```python
import torch

def _softmax(x, axis=-1):
    return torch.softmax(x, dim=axis)
def _gelu(x):
    return torch.nn.functional.gelu(x, approximate="tanh")
def _silu(x):
    return torch.nn.functional.silu(x)
def _sigmoid(x):
    return torch.sigmoid(x)
def _layernorm(x, axis=-1, eps=1e-5):
    m = x.mean(dim=axis, keepdim=True)
    v = x.var(dim=axis, keepdim=True, unbiased=False)
    return (x - m) / torch.sqrt(v + eps)
def _scatter_add(tgt, idx, src, axis=0):
    return tgt.clone().index_add_(axis, idx, src)
def _segment_sum(src, seg, n):
    out = torch.zeros((n,) + src.shape[1:], dtype=src.dtype)
    return out.index_add_(0, seg, src)
def _pad(x, pw):
    flat = tuple(v for pair in reversed(pw) for v in pair)
    return torch.nn.functional.pad(x, flat)

kernel_name = 'gated_mix__sliding_block_cached__dense_activation_gelu__decode'

def setup_inputs():

    _w = (lambda a: (lambda t: t.to(torch.bfloat16) if t.is_floating_point() else t)(torch.as_tensor(a)))
    def _A_setup():
        B, Sq, D = 1, 1, 576
        Hq, Hkv, Sk, Dh = 32, 16, 65536, 128
        assert Hq % Hkv == 0, (Hq, Hkv)
        return {
            "x": _w((lambda *s: torch.randn(*s, dtype=torch.bfloat16) * 0.05)(B, Sq, D)),
            "k_cache": _w((lambda *s: torch.randn(*s, dtype=torch.bfloat16) * 3.2)(B, Hkv, Sk, Dh)),
            "v_cache": _w((lambda *s: torch.randn(*s, dtype=torch.bfloat16) * 0.1)(B, Hkv, Sk, Dh)),
            "wq": _w((lambda *s: torch.randn(*s, dtype=torch.bfloat16) * 3.2)(D, Hq * Dh) * (D ** -0.5)),
            "wo": _w((lambda *s: torch.randn(*s, dtype=torch.bfloat16) * 0.1)(Hq * Dh, D) * ((Hq * Dh) ** -0.5)),
        }
    _A_in = _A_setup()

    def _B_setup():
        B, S, D, F = 1, 1, 576, 4608
        return {
            "x": _w((lambda *s: torch.randn(*s, dtype=torch.bfloat16) * 0.05)(B, S, D)),
            "w1": _w((lambda *s: torch.randn(*s, dtype=torch.bfloat16) * 0.1)(D, F) * (D ** -0.5)),
            "b1": _w((lambda *s: torch.randn(*s, dtype=torch.bfloat16) * 0.1)(F) * 0.01),
            "w2": _w((lambda *s: torch.randn(*s, dtype=torch.bfloat16) * 0.1)(F, D) * (F ** -0.5)),
            "b2": _w((lambda *s: torch.randn(*s, dtype=torch.bfloat16) * 0.05)(D) * 0.01),
        }
    _B_in = _B_setup()

    return {
        "A_x": _A_in["x"],
        "A_k_cache": _A_in["k_cache"],
        "A_v_cache": _A_in["v_cache"],
        "A_wq": _A_in["wq"],
        "A_wo": _A_in["wo"],
        "B_x": _B_in["x"],
        "B_w1": _B_in["w1"],
        "B_b1": _B_in["b1"],
        "B_w2": _B_in["w2"],
        "B_b2": _B_in["b2"],
        "gate_w": _w((lambda *s: torch.randn(*s, dtype=torch.bfloat16) * 0.05)(576) * 16.0),
    }

def reference(A_x, A_k_cache, A_v_cache, A_wq, A_wo, B_x, B_w1, B_b1, B_w2, B_b2, gate_w):
    def _A_ref(x, k_cache, v_cache, wq, wo):
        B, Sq, D = x.shape
        Hq, Dh = 32, 128
        Hkv, Sk = k_cache.shape[1], k_cache.shape[2]
        W = min(4096, max(256, Sk // 4))
        rep = Hq // Hkv
        q = (lambda x, *d: x.permute(*d))((x @ wq).reshape(B, Sq, Hq, Dh), 0, 2, 1, 3)
        k = (lambda x, n, axis: torch.repeat_interleave(x, n, dim=axis))(k_cache[:, :, Sk - W:, :], rep, axis=1)
        v = (lambda x, n, axis: torch.repeat_interleave(x, n, dim=axis))(v_cache[:, :, Sk - W:, :], rep, axis=1)
        scores = torch.einsum("bhqd,bhkd->bhqk", q, k) * (Dh ** -0.5)
        p = _softmax(scores, axis=-1)
        o = torch.einsum("bhqk,bhkd->bhqd", p, v)
        return (lambda x, *d: x.permute(*d))(o, 0, 2, 1, 3).reshape(B, Sq, Hq * Dh) @ wo

    def _B_ref(x, w1, b1, w2, b2):
        h = torch.einsum("bsd,df->bsf", x, w1) + b1
        h = _gelu(h)
        return torch.einsum("bsf,fd->bsd", h, w2) + b2

    x = A_x
    g = _sigmoid((x * gate_w).sum(-1, keepdims=True))
    a = _A_ref(x, A_k_cache, A_v_cache, A_wq, A_wo)
    b = _B_ref(x, B_w1, B_b1, B_w2, B_b2)
    return g * a + (1 - g) * b
```

```asm
; @launch grid=(256,1,1) block=(384,1,1) lds=70496
.amdgcn_target "amdgcn-amd-amdhsa--gfx950"
.text
.p2align 12
.fill 832, 4, 0xbf810000
.globl gated_mix__sliding_block_cached__dense_activation_gelu__decode_kernel
.p2align 8
.type gated_mix__sliding_block_cached__dense_activation_gelu__decode_kernel,@function
gated_mix__sliding_block_cached__dense_activation_gelu__decode_kernel:
    s_load_dwordx16 s[4:19], s[0:1], 0
    s_load_dwordx8 s[20:27], s[0:1], 64
    s_load_dwordx4 s[28:31], s[0:1], 96
    s_cmp_ge_u32 s2, 256
    s_cbranch_scc1 L_end
    v_lshrrev_b32 v1, 6, v0
    v_lshrrev_b32 v11, 4, v0
    v_readfirstlane_b32 s3, v1
    s_and_b32 s100, s2, 7
    s_lshl_b32 s100, s100, 5
    s_lshr_b32 s52, s2, 3
    s_or_b32 s100, s100, s52
    v_and_b32 v10, 15, v0
    s_mov_b32 s59, 33554432
    s_cmp_ge_u32 s3, 4
    s_cbranch_scc1 L_stub
    s_bfe_u32 s52, s100, 0x20001
    s_lshl_b32 s52, s52, 2
    s_add_u32 s52, s52, s3
    s_mul_i32 s52, s52, 36
    v_and_b32 v9, 3, v11
    v_add_u32 v11, s52, v9
    s_and_b32 s56, s100, 1
    s_add_u32 s56, s56, 8
    s_lshl_b32 s56, s56, 10
    s_mul_i32 s34, s56, 576
    s_mov_b32 s35, 0x20000
    s_movk_i32 s38, 1152
    s_mov_b32 s39, s35
    s_and_b32 s57, s100, 0x18
    s_lshr_b32 s57, 0x01030200, s57
    s_and_b32 s57, s57, 3
    s_lshr_b32 s58, s100, 5
    s_lshl_b32 s58, s58, 2
    s_add_u32 s58, s58, s57
    s_lshl_b32 s58, s58, 8
    v_mul_u32_u24 v16, s56, v11
    v_lshl_add_u32 v16, v10, 4, v16
    s_lshl_b32 s56, s56, 2
    v_lshrrev_b32 v12, 3, v0
    s_and_b32 s53, s100, 31
    s_mul_i32 s53, s53, 24
    v_cmp_gt_u32 vcc, 24, v12
    v_add_u32 v12, s53, v12
    v_mul_u32_u24 v13, 9216, v12
    v_and_b32 v14, 7, v0
    v_lshl_add_u32 v13, v14, 4, v13
    v_mov_b32 v14, 1073741824
    v_cndmask_b32 v13, v14, v13, vcc
    s_lshr_b32 s69, s100, 5
    s_lshl_b32 s69, s69, 7
    s_add_u32 s69, s69, 8192
    s_mov_b32 s46, 5308416
    s_mov_b32 s47, s35
    s_bitcmp0_b32 s100, 0
    s_waitcnt lgkmcnt(0)
    s_cselect_b64 s[32:33], s[10:11], s[16:17]
    buffer_load_dwordx4 v[52:55], v16, s[32:35], s58 offen nt
    s_add_u32 s58, s58, s56
    buffer_load_dwordx4 v[56:59], v16, s[32:35], s58 offen nt
    s_add_u32 s58, s58, s56
    buffer_load_dwordx4 v[60:63], v16, s[32:35], s58 offen nt
    s_add_u32 s58, s58, s56
    buffer_load_dwordx4 v[64:67], v16, s[32:35], s58 offen nt
    s_add_u32 s58, s58, s56
    buffer_load_dwordx4 v[68:71], v16, s[32:35], s58 offen nt
    s_add_u32 s58, s58, s56
    buffer_load_dwordx4 v[72:75], v16, s[32:35], s58 offen nt
    s_add_u32 s58, s58, s56
    buffer_load_dwordx4 v[76:79], v16, s[32:35], s58 offen nt
    s_add_u32 s58, s58, s56
    buffer_load_dwordx4 v[80:83], v16, s[32:35], s58 offen nt
    s_add_u32 s58, s58, s56
    buffer_load_dwordx4 v[84:87], v16, s[32:35], s58 offen nt
    s_mov_b64 s[44:45], s[16:17]
    buffer_load_dwordx4 v[152:155], v13, s[44:47], s69 offen nt
    s_mov_b64 s[36:37], s[4:5]
    s_mov_b64 s[22:23], s[12:13]
    s_mov_b64 s[40:41], s[6:7]
    s_mov_b32 s42, 268435456
    s_mov_b32 s43, 0x20000
    s_mov_b64 s[44:45], s[8:9]
    s_mov_b32 s46, 268435456
    s_mov_b32 s47, 0x20000
    s_mov_b64 s[48:49], s[30:31]
    s_mov_b32 s50, 1073741824
    s_mov_b32 s51, 0x20000
    s_lshl_b32 s52, s52, 1
    s_add_u32 s57, s52, 64
    s_lshl_b32 s56, s3, 3
    s_add_u32 s53, s53, s56
    s_lshl_b32 s53, s53, 1
    s_buffer_load_dwordx16 s[4:19], s[36:39], s52
    s_buffer_load_dwordx2 s[26:27], s[36:39], s57
    s_buffer_load_dword s28, s[36:39], s53
    s_add_u32 s53, s53, 4
    s_buffer_load_dword s29, s[36:39], s53
    s_add_u32 s53, s53, 4
    s_buffer_load_dword s30, s[36:39], s53
    s_add_u32 s53, s53, 4
    s_buffer_load_dword s31, s[36:39], s53
    s_barrier
    v_and_b32 v0, 63, v0
    s_lshr_b32 s54, s100, 4
    s_lshl_b32 s54, s54, 24
    s_and_b32 s52, s100, 15
    s_lshl_b32 s57, s52, 16
    s_add_u32 s54, s54, s57
    s_lshl_b32 s57, s3, 10
    s_add_u32 s54, s54, s57
    s_add_u32 s54, s54, 15728640
    s_mul_i32 s52, s52, 1
    s_lshr_b32 s57, s100, 4
    s_mul_i32 s57, s57, 5
    s_add_u32 s52, s52, s57
    s_and_b32 s52, s52, 15
    s_lshl_b32 s52, s52, 12
    s_add_u32 s55, s54, s52
    s_lshl_b32 s57, s3, 14
    s_mov_b32 m0, s57
    v_lshlrev_b32 v12, 2, v9
    v_xor_b32 v12, v12, v10
    v_lshlrev_b32 v12, 4, v12
    v_lshl_add_u32 v19, v9, 8, v12
    v_xor_b32 v20, 16, v19
    v_xor_b32 v21, 32, v19
    v_xor_b32 v22, 48, v19
    v_lshlrev_b32 v23, 4, v0
    v_and_b32 v11, 1, v10
    v_cmp_eq_u32 vcc, 1, v11
    v_mov_b32 v12, 0x0c0c0100
    v_mov_b32 v13, 0x01000c0c
    v_cndmask_b32 v12, v12, v13, vcc
    v_mov_b32 v14, 0x0c0c0302
    v_mov_b32 v13, 0x03020c0c
    v_cndmask_b32 v13, v14, v13, vcc
    v_bfe_u32 v11, v10, 1, 2
    v_mov_b32 v14, 0x0c0c0c0c
    v_cmp_eq_u32 vcc, 0, v11
    s_nop 1
    v_cndmask_b32 v1, v14, v12, vcc
    v_cndmask_b32 v5, v14, v13, vcc
    v_cmp_eq_u32 vcc, 1, v11
    s_nop 1
    v_cndmask_b32 v2, v14, v12, vcc
    v_cndmask_b32 v6, v14, v13, vcc
    v_cmp_eq_u32 vcc, 2, v11
    s_nop 1
    v_cndmask_b32 v3, v14, v12, vcc
    v_cndmask_b32 v7, v14, v13, vcc
    v_cmp_eq_u32 vcc, 3, v11
    s_nop 1
    v_cndmask_b32 v4, v14, v12, vcc
    v_cndmask_b32 v8, v14, v13, vcc
    s_mov_b32 s61, 0x7060500
    s_mov_b32 s62, 0x7060501
    s_mov_b32 s63, 0x7060502
    s_mov_b32 s64, 0x7060503
    s_lshl_b32 s57, s3, 10
    s_add_u32 s57, s57, 66400
    v_add_u32 v17, s57, v23
    v_and_b32 v12, 7, v0
    v_lshlrev_b32 v12, 4, v12
    v_lshl_add_u32 v12, v9, 7, v12
    v_add_u32 v18, s57, v12
    s_lshl_b32 s57, s3, 2
    s_add_u32 s57, s57, 66048
    v_mov_b32 v15, s57
    v_sub_u32 v12, v5, v1
    v_mul_lo_u32 v12, v12, v9
    v_add_u32 v160, v12, v1
    v_sub_u32 v12, v6, v2
    v_mul_lo_u32 v12, v12, v9
    v_add_u32 v161, v12, v2
    v_sub_u32 v12, v7, v3
    v_mul_lo_u32 v12, v12, v9
    v_add_u32 v162, v12, v3
    v_sub_u32 v12, v8, v4
    v_mul_lo_u32 v12, v12, v9
    v_add_u32 v163, v12, v4
    v_mov_b32 v26, 0
    v_and_b32 v12, 8, v0
    v_lshlrev_b32 v12, 1, v12
    s_waitcnt vmcnt(5)
    buffer_load_dwordx4 v19, s[40:43], s55 offen nt lds
    s_add_u32 m0, m0, 1024
    s_add_u32 s52, s52, 4096
    s_and_b32 s52, s52, 0xffff
    s_add_u32 s55, s54, s52
    s_waitcnt vmcnt(5)
    buffer_load_dwordx4 v20, s[40:43], s55 offen nt lds
    s_add_u32 m0, m0, 1024
    s_add_u32 s52, s52, 4096
    s_and_b32 s52, s52, 0xffff
    s_add_u32 s55, s54, s52
    s_waitcnt vmcnt(5)
    buffer_load_dwordx4 v21, s[40:43], s55 offen nt lds
    s_add_u32 m0, m0, 1024
    s_add_u32 s52, s52, 4096
    s_and_b32 s52, s52, 0xffff
    s_add_u32 s55, s54, s52
    s_waitcnt lgkmcnt(0)
    v_mov_b32 v165, s28
    s_mov_b32 exec_lo, 0xffff0000
    v_mov_b32 v165, s29
    s_mov_b32 exec_lo, 0
    v_mov_b32 v165, s30
    s_mov_b32 exec_hi, 0xffff0000
    v_mov_b32 v165, s31
    s_mov_b64 exec, -1
    v_lshrrev_b32 v165, v12, v165
    v_perm_b32 v156, v165, v165, v1
    v_perm_b32 v157, v165, v165, v2
    v_perm_b32 v158, v165, v165, v3
    v_perm_b32 v159, v165, v165, v4
    v_mov_b32 v164, s5
    v_perm_b32 v88, v164, s4, v160
    v_perm_b32 v89, v164, s4, v161
    v_perm_b32 v90, v164, s4, v162
    v_perm_b32 v91, v164, s4, v163
    v_mov_b32 v164, s7
    v_perm_b32 v92, v164, s6, v160
    v_perm_b32 v93, v164, s6, v161
    v_perm_b32 v94, v164, s6, v162
    v_perm_b32 v95, v164, s6, v163
    v_mov_b32 v164, s9
    v_perm_b32 v96, v164, s8, v160
    v_perm_b32 v97, v164, s8, v161
    v_perm_b32 v98, v164, s8, v162
    v_perm_b32 v99, v164, s8, v163
    v_mov_b32 v164, s11
    v_perm_b32 v100, v164, s10, v160
    v_perm_b32 v101, v164, s10, v161
    v_perm_b32 v102, v164, s10, v162
    v_perm_b32 v103, v164, s10, v163
    v_mov_b32 v164, s13
    v_perm_b32 v104, v164, s12, v160
    v_perm_b32 v105, v164, s12, v161
    v_perm_b32 v106, v164, s12, v162
    v_perm_b32 v107, v164, s12, v163
    v_mov_b32 v164, s15
    v_perm_b32 v108, v164, s14, v160
    v_perm_b32 v109, v164, s14, v161
    v_perm_b32 v110, v164, s14, v162
    v_perm_b32 v111, v164, s14, v163
    v_mov_b32 v164, s17
    v_perm_b32 v112, v164, s16, v160
    v_perm_b32 v113, v164, s16, v161
    v_perm_b32 v114, v164, s16, v162
    v_perm_b32 v115, v164, s16, v163
    v_mov_b32 v164, s19
    v_perm_b32 v116, v164, s18, v160
    v_perm_b32 v117, v164, s18, v161
    v_perm_b32 v118, v164, s18, v162
    v_perm_b32 v119, v164, s18, v163
    v_mov_b32 v164, s27
    v_perm_b32 v120, v164, s26, v160
    v_perm_b32 v121, v164, s26, v161
    v_perm_b32 v122, v164, s26, v162
    v_perm_b32 v123, v164, s26, v163
    s_waitcnt vmcnt(5)
    buffer_load_dwordx4 v22, s[40:43], s55 offen nt lds
    s_add_u32 m0, m0, 1024
    s_add_u32 s52, s52, 4096
    s_and_b32 s52, s52, 0xffff
    s_add_u32 s55, s54, s52
    s_waitcnt vmcnt(5)
    buffer_load_dwordx4 v19, s[40:43], s55 offen nt lds
    s_add_u32 m0, m0, 1024
    s_add_u32 s52, s52, 4096
    s_and_b32 s52, s52, 0xffff
    s_add_u32 s55, s54, s52
    s_waitcnt vmcnt(5)
    v_mfma_f32_16x16x32_bf16 v[44:47], v[156:159], v[152:155], 0
    v_mfma_f32_16x16x32_bf16 v[40:43], v[88:91], v[52:55], 0
    v_mfma_f32_16x16x32_bf16 v[40:43], v[92:95], v[56:59], v[40:43]
    v_mfma_f32_16x16x32_bf16 v[40:43], v[96:99], v[60:63], v[40:43]
    v_mfma_f32_16x16x32_bf16 v[40:43], v[100:103], v[64:67], v[40:43]
    v_mfma_f32_16x16x32_bf16 v[40:43], v[104:107], v[68:71], v[40:43]
    v_mfma_f32_16x16x32_bf16 v[40:43], v[108:111], v[72:75], v[40:43]
    v_mfma_f32_16x16x32_bf16 v[40:43], v[112:115], v[76:79], v[40:43]
    v_mfma_f32_16x16x32_bf16 v[40:43], v[116:119], v[80:83], v[40:43]
    v_mfma_f32_16x16x32_bf16 v[40:43], v[120:123], v[84:87], v[40:43]
    s_mov_b32 exec_lo, 0x00ff00ff
    s_mov_b32 exec_hi, 0xff00ff00
    ds_write_b128 v18, v[44:47] offset:512
    s_mov_b32 exec_lo, -1
    s_mov_b32 exec_hi, 0
    s_nop 3
    ds_write_b128 v17, v[40:43]
    s_mov_b64 exec, 1
    v_add_u32 v26, 1, v26
    ds_write_b32 v15, v26
    s_mov_b64 exec, -1
    s_waitcnt vmcnt(5)
    buffer_load_dwordx4 v20, s[40:43], s55 offen nt lds
    s_add_u32 m0, m0, 1024
    s_add_u32 s52, s52, 4096
    s_and_b32 s52, s52, 0xffff
    s_add_u32 s55, s54, s52
    s_waitcnt vmcnt(5)
    buffer_load_dwordx4 v21, s[40:43], s55 offen nt lds
    s_add_u32 m0, m0, 1024
    s_add_u32 s52, s52, 4096
    s_and_b32 s52, s52, 0xffff
    s_add_u32 s55, s54, s52
    s_waitcnt vmcnt(5)
    buffer_load_dwordx4 v22, s[40:43], s55 offen nt lds
    s_add_u32 m0, m0, 1024
    s_add_u32 s52, s52, 4096
    s_and_b32 s52, s52, 0xffff
    s_add_u32 s55, s54, s52
    s_waitcnt vmcnt(5)
    buffer_load_dwordx4 v19, s[40:43], s55 offen nt lds
    s_add_u32 m0, m0, 1024
    s_add_u32 s52, s52, 4096
    s_and_b32 s52, s52, 0xffff
    s_add_u32 s55, s54, s52
    s_waitcnt vmcnt(5)
    buffer_load_dwordx4 v20, s[40:43], s55 offen nt lds
    s_add_u32 m0, m0, 1024
    s_add_u32 s52, s52, 4096
    s_and_b32 s52, s52, 0xffff
    s_add_u32 s55, s54, s52
    s_waitcnt vmcnt(5)
    buffer_load_dwordx4 v21, s[40:43], s55 offen nt lds
    s_add_u32 m0, m0, 1024
    s_add_u32 s52, s52, 4096
    s_and_b32 s52, s52, 0xffff
    s_add_u32 s55, s54, s52
    s_waitcnt vmcnt(5)
    buffer_load_dwordx4 v22, s[40:43], s55 offen nt lds
    s_add_u32 m0, m0, 1024
    s_add_u32 s52, s52, 4096
    s_and_b32 s52, s52, 0xffff
    s_add_u32 s55, s54, s52
    s_mov_b64 exec, 1
    v_add_u32 v26, 1, v26
    ds_write_b32 v15, v26
    s_mov_b64 exec, -1
    s_waitcnt vmcnt(5)
    buffer_load_dwordx4 v19, s[40:43], s55 offen nt lds
    s_add_u32 m0, m0, 1024
    s_add_u32 s52, s52, 4096
    s_and_b32 s52, s52, 0xffff
    s_add_u32 s55, s54, s52
    s_waitcnt vmcnt(5)
    buffer_load_dwordx4 v20, s[40:43], s55 offen nt lds
    s_add_u32 m0, m0, 1024
    s_add_u32 s52, s52, 4096
    s_and_b32 s52, s52, 0xffff
    s_add_u32 s55, s54, s52
    s_mov_b64 exec, 1
    v_add_u32 v26, 1, v26
    ds_write_b32 v15, v26
    s_mov_b64 exec, -1
    s_waitcnt vmcnt(5)
    buffer_load_dwordx4 v21, s[40:43], s55 offen nt lds
    s_add_u32 m0, m0, 1024
    s_add_u32 s52, s52, 4096
    s_and_b32 s52, s52, 0xffff
    s_add_u32 s55, s54, s52
    s_waitcnt vmcnt(5)
    buffer_load_dwordx4 v22, s[40:43], s55 offen nt lds
    s_add_u32 m0, m0, 1024
    s_add_u32 s52, s52, 4096
    s_and_b32 s52, s52, 0xffff
    s_add_u32 s55, s54, s52
    s_lshl_b32 s57, s3, 8
    v_lshl_add_u32 v11, v10, 4, s57
    v_mul_u32_u24 v12, 1152, v9
    v_lshl_add_u32 v17, v12, 2, v11
    v_add_u32 v12, v12, v11
    v_cmp_gt_u32 vcc, 2, v9
    v_mov_b32 v13, 1073741824
    s_nop 0
    v_cndmask_b32 v18, v13, v12, vcc
    s_mov_b64 s[32:33], s[22:23]
    s_mov_b32 s34, 4718592
    s_mov_b32 s35, 0x20000
    s_mov_b64 s[36:37], s[20:21]
    s_mov_b32 s38, 5308416
    s_mov_b32 s39, 0x20000
    s_mul_i32 s68, s100, 18432
    s_mul_i32 s69, s100, 2304
    s_add_u32 s69, s69, 4718592
    v_lshrrev_b32 v11, 3, v0
    v_lshlrev_b32 v11, 12, v11
    s_mov_b32 s70, -1
    s_lshl_b32 s57, s3, 14
    v_and_b32 v12, 7, v0
    v_lshl_add_u32 v24, v12, 4, v11
    s_mov_b32 s71, 0
    s_lshr_b32 s56, s100, 5
    s_mul_i32 s56, s56, 73728
    s_add_u32 s56, s56, s57
    s_and_b32 s57, s100, 31
    s_lshl_b32 s57, s57, 7
    s_add_u32 s56, s56, s57
    s_add_u32 s56, s56, 655360
    v_lshlrev_b32 v25, 4, v9
    v_add_u32 v25, 66112, v25
    v_and_b32 v11, 3, v10
    v_lshrrev_b32 v12, 2, v10
    v_lshl_add_u32 v11, v11, 2, v12
    v_lshlrev_b32 v11, 8, v11
    s_lshl_b32 s57, s3, 14
    v_add_u32 v11, s57, v11
    v_xor_b32 v12, v9, v10
    v_lshl_add_u32 v27, v12, 4, v11
    v_xor_b32 v28, 64, v27
    v_xor_b32 v29, 128, v27
    v_xor_b32 v30, 192, v27
    s_waitcnt vmcnt(5)
    buffer_load_dwordx4 v[88:91], v23, s[44:47], s55 offen nt
    s_add_u32 s52, s52, 4096
    s_and_b32 s52, s52, 0xffff
    s_add_u32 s55, s54, s52
    s_waitcnt vmcnt(5)
    buffer_load_dwordx4 v[92:95], v23, s[44:47], s55 offen nt
    s_add_u32 s52, s52, 4096
    s_and_b32 s52, s52, 0xffff
    s_add_u32 s55, s54, s52
    s_waitcnt vmcnt(5)
    buffer_load_dwordx4 v[96:99], v23, s[44:47], s55 offen nt
    s_add_u32 s52, s52, 4096
    s_and_b32 s52, s52, 0xffff
    s_add_u32 s55, s54, s52
    s_waitcnt vmcnt(5)
    buffer_load_dwordx4 v[100:103], v23, s[44:47], s55 offen nt
    s_add_u32 s52, s52, 4096
    s_and_b32 s52, s52, 0xffff
    s_add_u32 s55, s54, s52
    s_waitcnt vmcnt(5)
    buffer_load_dwordx4 v[104:107], v23, s[44:47], s55 offen nt
    s_add_u32 s52, s52, 4096
    s_and_b32 s52, s52, 0xffff
    s_add_u32 s55, s54, s52
    s_waitcnt vmcnt(5)
    buffer_load_dwordx4 v[108:111], v23, s[44:47], s55 offen nt
    s_add_u32 s52, s52, 4096
    s_and_b32 s52, s52, 0xffff
    s_add_u32 s55, s54, s52
    buffer_load_dwordx4 v[112:115], v23, s[44:47], s55 offen nt
    s_add_u32 s52, s52, 4096
    s_and_b32 s52, s52, 0xffff
    s_add_u32 s55, s54, s52
    buffer_load_dwordx4 v[116:119], v23, s[44:47], s55 offen nt
    s_add_u32 s52, s52, 4096
    s_and_b32 s52, s52, 0xffff
    s_add_u32 s55, s54, s52
    v_lshrrev_b32 v13, 3, v10
    v_lshlrev_b32 v11, 8, v13
    v_lshl_add_u32 v11, v9, 4, v11
    v_add_u32 v11, 65536, v11
    v_lshlrev_b32 v13, 5, v13
    s_lshl_b32 s57, s3, 2
    s_add_u32 s57, s57, 66240
    v_add_u32 v14, s57, v13
    v_mov_b32 v13, 66064
    s_waitcnt vmcnt(8)
    ds_read_b128 v[52:55], v27 offset:0
    ds_read_b128 v[56:59], v28 offset:0
    ds_read_b128 v[60:63], v29 offset:0
    ds_read_b128 v[64:67], v30 offset:0
    ds_read_b128 v[68:71], v27 offset:4096
    ds_read_b128 v[72:75], v28 offset:4096
    ds_read_b128 v[76:79], v29 offset:4096
    ds_read_b128 v[80:83], v30 offset:4096
L_wq:
    ds_read_b32 v12, v13
    ds_read_b128 v[136:139], v11 offset:0
    ds_read_b128 v[140:143], v11 offset:64
    ds_read_b128 v[144:147], v11 offset:128
    ds_read_b128 v[148:151], v11 offset:192
    s_waitcnt lgkmcnt(0)
    v_cmp_eq_u32 vcc, 1, v12
    s_cbranch_vccnz L_wq_ok
    s_sleep 1
    s_sub_u32 s59, s59, 2
    s_cbranch_scc0 L_wq
    s_mov_b32 s59, 0
L_wq_ok:
    v_mfma_f32_16x16x32_bf16 v[152:155], v[52:55], v[136:139], 0
    v_mfma_f32_16x16x32_bf16 v[152:155], v[56:59], v[140:143], v[152:155]
    v_mfma_f32_16x16x32_bf16 v[152:155], v[60:63], v[144:147], v[152:155]
    v_mfma_f32_16x16x32_bf16 v[152:155], v[64:67], v[148:151], v[152:155]
    ds_read_b128 v[52:55], v27 offset:8192
    ds_read_b128 v[56:59], v28 offset:8192
    ds_read_b128 v[60:63], v29 offset:8192
    ds_read_b128 v[64:67], v30 offset:8192
    v_mfma_f32_16x16x32_bf16 v[156:159], v[68:71], v[136:139], 0
    v_mfma_f32_16x16x32_bf16 v[156:159], v[72:75], v[140:143], v[156:159]
    v_mfma_f32_16x16x32_bf16 v[156:159], v[76:79], v[144:147], v[156:159]
    v_mfma_f32_16x16x32_bf16 v[156:159], v[80:83], v[148:151], v[156:159]
    ds_read_b128 v[68:71], v27 offset:12288
    ds_read_b128 v[72:75], v28 offset:12288
    ds_read_b128 v[76:79], v29 offset:12288
    ds_read_b128 v[80:83], v30 offset:12288
    s_waitcnt lgkmcnt(4)
    v_mfma_f32_16x16x32_bf16 v[160:163], v[52:55], v[136:139], 0
    v_mfma_f32_16x16x32_bf16 v[160:163], v[56:59], v[140:143], v[160:163]
    v_mfma_f32_16x16x32_bf16 v[160:163], v[60:63], v[144:147], v[160:163]
    v_mfma_f32_16x16x32_bf16 v[160:163], v[64:67], v[148:151], v[160:163]
    s_waitcnt lgkmcnt(0)
    v_mfma_f32_16x16x32_bf16 v[164:167], v[68:71], v[136:139], 0
    v_mfma_f32_16x16x32_bf16 v[164:167], v[72:75], v[140:143], v[164:167]
    v_mfma_f32_16x16x32_bf16 v[164:167], v[76:79], v[144:147], v[164:167]
    v_mfma_f32_16x16x32_bf16 v[164:167], v[80:83], v[148:151], v[164:167]
    buffer_load_dwordx4 v[120:123], v23, s[44:47], s55 offen nt
    s_add_u32 s52, s52, 4096
    s_and_b32 s52, s52, 0xffff
    s_add_u32 s55, s54, s52
    v_max3_f32 v48, v152, v153, v154
    v_max3_f32 v48, v48, v155, v156
    v_max3_f32 v48, v48, v157, v158
    v_max3_f32 v48, v48, v159, v160
    v_max3_f32 v48, v48, v161, v162
    s_nop 3
    v_max3_f32 v48, v48, v163, v164
    v_max3_f32 v48, v48, v165, v166
    v_max_f32 v48, v48, v167
    v_mov_b32 v50, v48
    s_nop 1
    v_permlane16_swap_b32 v48, v50
    v_max_f32 v48, v48, v50
    v_mov_b32 v50, v48
    s_nop 1
    v_permlane32_swap_b32 v48, v50
    v_max_f32 v48, v48, v50
    s_mov_b32 s57, 0x3e0293ee
    v_mul_f32 v50, s57, v48
    v_fma_f32 v152, v152, s57, -v50
    v_fma_f32 v153, v153, s57, -v50
    v_fma_f32 v154, v154, s57, -v50
    v_fma_f32 v155, v155, s57, -v50
    v_fma_f32 v156, v156, s57, -v50
    v_fma_f32 v157, v157, s57, -v50
    v_fma_f32 v158, v158, s57, -v50
    v_fma_f32 v159, v159, s57, -v50
    v_fma_f32 v160, v160, s57, -v50
    v_fma_f32 v161, v161, s57, -v50
    v_fma_f32 v162, v162, s57, -v50
    v_fma_f32 v163, v163, s57, -v50
    v_fma_f32 v164, v164, s57, -v50
    v_fma_f32 v165, v165, s57, -v50
    v_fma_f32 v166, v166, s57, -v50
    v_fma_f32 v167, v167, s57, -v50
    buffer_load_dwordx4 v[124:127], v23, s[44:47], s55 offen nt
    s_add_u32 s52, s52, 4096
    s_and_b32 s52, s52, 0xffff
    s_add_u32 s55, s54, s52
    v_exp_f32 v152, v152
    v_exp_f32 v153, v153
    v_exp_f32 v154, v154
    v_exp_f32 v155, v155
    v_exp_f32 v156, v156
    v_exp_f32 v157, v157
    v_exp_f32 v158, v158
    v_exp_f32 v159, v159
    v_exp_f32 v160, v160
    v_exp_f32 v161, v161
    v_exp_f32 v162, v162
    v_exp_f32 v163, v163
    v_exp_f32 v164, v164
    v_exp_f32 v165, v165
    v_exp_f32 v166, v166
    v_exp_f32 v167, v167
    buffer_load_dwordx4 v[128:131], v23, s[44:47], s55 offen nt
    s_add_u32 s52, s52, 4096
    s_and_b32 s52, s52, 0xffff
    s_add_u32 s55, s54, s52
    v_pk_add_f32 v[52:53], v[152:153], v[156:157]
    v_pk_add_f32 v[54:55], v[154:155], v[158:159]
    v_pk_add_f32 v[56:57], v[160:161], v[164:165]
    v_pk_add_f32 v[58:59], v[162:163], v[166:167]
    v_pk_add_f32 v[52:53], v[52:53], v[56:57]
    v_pk_add_f32 v[54:55], v[54:55], v[58:59]
    v_add_f32 v52, v52, v53
    v_add_f32 v54, v54, v55
    v_add_f32 v49, v52, v54
    v_mov_b32 v50, v49
    s_nop 1
    v_permlane16_swap_b32 v49, v50
    v_add_f32 v49, v49, v50
    v_mov_b32 v50, v49
    s_nop 1
    v_permlane32_swap_b32 v49, v50
    v_add_f32 v49, v49, v50
    s_mov_b64 exec, 0x101
    ds_write2_b32 v14, v48, v49 offset0:0 offset1:4
    s_mov_b64 exec, 1
    v_add_u32 v26, 1, v26
    ds_write_b32 v15, v26
    s_mov_b64 exec, -1
    v_cvt_pk_bf16_f32 v152, v152, v153
    v_cvt_pk_bf16_f32 v153, v154, v155
    v_cvt_pk_bf16_f32 v154, v156, v157
    v_cvt_pk_bf16_f32 v155, v158, v159
    v_cvt_pk_bf16_f32 v156, v160, v161
    v_cvt_pk_bf16_f32 v157, v162, v163
    v_cvt_pk_bf16_f32 v158, v164, v165
    v_cvt_pk_bf16_f32 v159, v166, v167
    s_branch L_cont
    .p2align 12, 0
L_stub:
    s_branch L_service
L_cont:
    v_lshrrev_b32 v11, 1, v9
    v_lshlrev_b32 v11, 9, v11
    v_lshl_add_u32 v11, v10, 5, v11
    v_and_b32 v12, 1, v9
    v_lshl_add_u32 v11, v12, 4, v11
    s_lshl_b32 s57, s3, 10
    s_add_u32 s57, s57, 66400
    v_add_u32 v11, s57, v11
    v_perm_b32 v32, v152, v152, v1
    v_perm_b32 v33, v152, v152, v2
    v_perm_b32 v34, v152, v152, v3
    v_perm_b32 v35, v152, v152, v4
    s_waitcnt vmcnt(10)
    s_nop 0
    v_mfma_f32_16x16x32_bf16 v[40:43], v[32:35], v[88:91], 0
    v_perm_b32 v36, v152, v152, v5
    v_perm_b32 v37, v152, v152, v6
    v_perm_b32 v38, v152, v152, v7
    v_perm_b32 v39, v152, v152, v8
    s_waitcnt vmcnt(9)
    s_nop 0
    v_mfma_f32_16x16x32_bf16 v[40:43], v[36:39], v[92:95], v[40:43]
    v_perm_b32 v32, v153, v153, v1
    v_perm_b32 v33, v153, v153, v2
    v_perm_b32 v34, v153, v153, v3
    v_perm_b32 v35, v153, v153, v4
    s_waitcnt vmcnt(8)
    s_nop 0
    v_mfma_f32_16x16x32_bf16 v[40:43], v[32:35], v[96:99], v[40:43]
    v_perm_b32 v36, v153, v153, v5
    v_perm_b32 v37, v153, v153, v6
    v_perm_b32 v38, v153, v153, v7
    v_perm_b32 v39, v153, v153, v8
    s_waitcnt vmcnt(7)
    s_nop 0
    v_mfma_f32_16x16x32_bf16 v[40:43], v[36:39], v[100:103], v[40:43]
    v_perm_b32 v32, v154, v154, v1
    v_perm_b32 v33, v154, v154, v2
    v_perm_b32 v34, v154, v154, v3
    v_perm_b32 v35, v154, v154, v4
    s_waitcnt vmcnt(6)
    s_nop 0
    v_mfma_f32_16x16x32_bf16 v[40:43], v[32:35], v[104:107], v[40:43]
    s_waitcnt vmcnt(6)
    buffer_load_dwordx4 v[132:135], v23, s[44:47], s55 offen nt
    s_add_u32 s52, s52, 4096
    s_and_b32 s52, s52, 0xffff
    s_add_u32 s55, s54, s52
    v_perm_b32 v36, v154, v154, v5
    v_perm_b32 v37, v154, v154, v6
    v_perm_b32 v38, v154, v154, v7
    v_perm_b32 v39, v154, v154, v8
    s_waitcnt vmcnt(6)
    s_nop 0
    v_mfma_f32_16x16x32_bf16 v[40:43], v[36:39], v[108:111], v[40:43]
    s_waitcnt vmcnt(6)
    buffer_load_dwordx4 v[136:139], v23, s[44:47], s55 offen nt
    s_add_u32 s52, s52, 4096
    s_and_b32 s52, s52, 0xffff
    s_add_u32 s55, s54, s52
    v_perm_b32 v32, v155, v155, v1
    v_perm_b32 v33, v155, v155, v2
    v_perm_b32 v34, v155, v155, v3
    v_perm_b32 v35, v155, v155, v4
    s_waitcnt vmcnt(6)
    s_nop 0
    v_mfma_f32_16x16x32_bf16 v[40:43], v[32:35], v[112:115], v[40:43]
    s_waitcnt vmcnt(6)
    buffer_load_dwordx4 v[140:143], v23, s[44:47], s55 offen nt
    s_add_u32 s52, s52, 4096
    s_and_b32 s52, s52, 0xffff
    s_add_u32 s55, s54, s52
    v_perm_b32 v36, v155, v155, v5
    v_perm_b32 v37, v155, v155, v6
    v_perm_b32 v38, v155, v155, v7
    v_perm_b32 v39, v155, v155, v8
    s_waitcnt vmcnt(6)
    s_nop 0
    v_mfma_f32_16x16x32_bf16 v[40:43], v[36:39], v[116:119], v[40:43]
    s_waitcnt vmcnt(6)
    buffer_load_dwordx4 v[144:147], v23, s[44:47], s55 offen nt
    s_add_u32 s52, s52, 4096
    s_and_b32 s52, s52, 0xffff
    s_add_u32 s55, s54, s52
    v_perm_b32 v32, v156, v156, v1
    v_perm_b32 v33, v156, v156, v2
    v_perm_b32 v34, v156, v156, v3
    v_perm_b32 v35, v156, v156, v4
    s_waitcnt vmcnt(6)
    s_nop 0
    v_mfma_f32_16x16x32_bf16 v[40:43], v[32:35], v[120:123], v[40:43]
    s_waitcnt vmcnt(6)
    buffer_load_dwordx4 v[148:151], v23, s[44:47], s55 offen nt
    s_mov_b64 exec, 1
    v_add_u32 v26, 1, v26
    ds_write_b32 v15, v26
    s_mov_b64 exec, -1
    v_perm_b32 v36, v156, v156, v5
    v_perm_b32 v37, v156, v156, v6
    v_perm_b32 v38, v156, v156, v7
    v_perm_b32 v39, v156, v156, v8
    s_waitcnt vmcnt(6)
    s_nop 0
    v_mfma_f32_16x16x32_bf16 v[40:43], v[36:39], v[124:127], v[40:43]
    v_lshrrev_b32 v12, 2, v0
    v_lshlrev_b32 v12, 10, v12
    v_and_b32 v13, 3, v0
    v_lshl_add_u32 v19, v13, 4, v12
    s_lshr_b32 s57, s100, 4
    s_and_b32 s58, s100, 15
    s_lshl_b32 s57, s57, 14
    s_lshl_b32 s58, s58, 6
    s_add_u32 s58, s57, s58
    s_add_u32 s58, s58, 327680
    v_mov_b32 v20, 66048
    v_lshrrev_b32 v12, 5, v0
    v_lshl_add_u32 v21, v12, 4, v20
    v_add_u32 v22, 66400, v23
    v_mov_b32 v165, 1
    s_and_b32 s53, s100, 15
    s_lshl_b32 s53, s53, 2
    s_lshl_b64 s[72:73], 15, s53
    v_lshl_add_u32 v14, v13, 4, v20
L_wf:
    ds_read_b32 v12, v20 offset:48
    ds_read_b128 v[160:163], v21 offset:256
    ds_read_b32 v31, v20 offset:52
    s_waitcnt lgkmcnt(0)
    v_cmp_ne_u32 vcc, 0, v12
    s_cbranch_vccnz L_wf_ok
    s_sleep 1
    s_sub_u32 s59, s59, 2
    s_cbranch_scc0 L_wf
    s_mov_b32 s59, 0
L_wf_ok:
    v_readfirstlane_b32 s101, v12
    v_perm_b32 v32, v157, v157, v1
    v_perm_b32 v33, v157, v157, v2
    v_perm_b32 v34, v157, v157, v3
    v_perm_b32 v35, v157, v157, v4
    s_waitcnt vmcnt(5)
    s_nop 0
    v_mfma_f32_16x16x32_bf16 v[40:43], v[32:35], v[128:131], v[40:43]
    v_perm_b32 v36, v157, v157, v5
    v_perm_b32 v37, v157, v157, v6
    v_perm_b32 v38, v157, v157, v7
    v_perm_b32 v39, v157, v157, v8
    s_waitcnt vmcnt(4)
    s_nop 0
    v_mfma_f32_16x16x32_bf16 v[40:43], v[36:39], v[132:135], v[40:43]
    v_perm_b32 v32, v158, v158, v1
    v_perm_b32 v33, v158, v158, v2
    v_perm_b32 v34, v158, v158, v3
    v_perm_b32 v35, v158, v158, v4
    s_waitcnt vmcnt(3)
    s_nop 0
    v_mfma_f32_16x16x32_bf16 v[40:43], v[32:35], v[136:139], v[40:43]
    v_perm_b32 v36, v158, v158, v5
    v_perm_b32 v37, v158, v158, v6
    v_perm_b32 v38, v158, v158, v7
    v_perm_b32 v39, v158, v158, v8
    s_waitcnt vmcnt(2)
    s_nop 0
    v_mfma_f32_16x16x32_bf16 v[40:43], v[36:39], v[140:143], v[40:43]
    s_waitcnt vmcnt(2)
    buffer_load_dwordx4 v[52:55], v17, s[36:39], s68 offen offset:0 nt
    v_perm_b32 v32, v159, v159, v1
    v_perm_b32 v33, v159, v159, v2
    v_perm_b32 v34, v159, v159, v3
    v_perm_b32 v35, v159, v159, v4
    s_waitcnt vmcnt(2)
    s_nop 0
    v_mfma_f32_16x16x32_bf16 v[40:43], v[32:35], v[144:147], v[40:43]
    s_waitcnt vmcnt(2)
    buffer_load_dwordx4 v[56:59], v17, s[36:39], s68 offen offset:1152 nt
    v_perm_b32 v36, v159, v159, v5
    v_perm_b32 v37, v159, v159, v6
    v_perm_b32 v38, v159, v159, v7
    v_perm_b32 v39, v159, v159, v8
    s_waitcnt vmcnt(2)
    s_nop 0
    v_mfma_f32_16x16x32_bf16 v[40:43], v[36:39], v[148:151], v[40:43]
    s_nop 7
    ds_write_b128 v11, v[40:43]
    s_mov_b64 exec, 1
    ds_add_rtn_u32 v164, v20, v165 offset:40
    s_mov_b64 exec, -1
    ds_read_b128 v[88:91], v22 offset:0
    ds_read_b128 v[92:95], v22 offset:1024
    ds_read_b128 v[96:99], v22 offset:2048
    ds_read_b128 v[100:103], v22 offset:3072
    s_waitcnt lgkmcnt(4)
    v_readfirstlane_b32 s57, v164
    s_cmp_lg_u32 s57, 3
    s_cbranch_scc1 L_notlast
    s_cmp_eq_u32 s101, 1
    s_waitcnt lgkmcnt(3)
    v_pk_mul_f32 v[88:89], v[88:89], v[160:161] op_sel_hi:[1,0]
    v_pk_mul_f32 v[90:91], v[90:91], v[160:161] op_sel_hi:[1,0]
    s_waitcnt lgkmcnt(2)
    v_pk_fma_f32 v[88:89], v[92:93], v[160:161], v[88:89] op_sel:[0,1,0] op_sel_hi:[1,1,1]
    v_pk_fma_f32 v[90:91], v[94:95], v[160:161], v[90:91] op_sel:[0,1,0] op_sel_hi:[1,1,1]
    s_waitcnt lgkmcnt(1)
    v_pk_fma_f32 v[88:89], v[96:97], v[162:163], v[88:89] op_sel_hi:[1,0,1]
    v_pk_fma_f32 v[90:91], v[98:99], v[162:163], v[90:91] op_sel_hi:[1,0,1]
    s_waitcnt lgkmcnt(0)
    v_pk_fma_f32 v[88:89], v[100:101], v[162:163], v[88:89] op_sel:[0,1,0] op_sel_hi:[1,1,1]
    v_pk_fma_f32 v[90:91], v[102:103], v[162:163], v[90:91] op_sel:[0,1,0] op_sel_hi:[1,1,1]
    v_perm_b32 v88, v88, v31, s61
    v_perm_b32 v89, v89, v31, s62
    v_perm_b32 v90, v90, v31, s63
    v_perm_b32 v91, v91, v31, s64
    s_cbranch_scc0 L_pubO_w
    buffer_store_dwordx4 v[88:91], v19, s[48:51], s58 offen
L_pubO_r:
    s_mov_b64 exec, s[72:73]
    ds_write_b128 v14, v[88:91] offset:288
    s_mov_b64 exec, 1
    ds_write_b32 v20, v165 offset:44
    s_mov_b64 exec, -1
L_notlast:
    s_mov_b32 s53, 0
    s_cmp_lg_u32 s53, 0
    s_cbranch_scc1 L_go18
    ds_read_b32 v12, v20 offset:44
    s_waitcnt lgkmcnt(0)
    v_readfirstlane_b32 s53, v12
    s_cmp_lg_u32 s53, 0
    s_cbranch_scc1 L_go18
    s_waitcnt vmcnt(2)
L_go18:
    s_waitcnt vmcnt(6)
    buffer_load_dwordx4 v[60:63], v17, s[36:39], s68 offen offset:2304 nt
    s_cmp_lg_u32 s53, 0
    s_cbranch_scc1 L_go19
    ds_read_b32 v12, v20 offset:44
    s_waitcnt lgkmcnt(0)
    v_readfirstlane_b32 s53, v12
    s_cmp_lg_u32 s53, 0
    s_cbranch_scc1 L_go19
    s_waitcnt vmcnt(2)
L_go19:
    s_waitcnt vmcnt(6)
    buffer_load_dwordx4 v[64:67], v17, s[36:39], s68 offen offset:3456 nt
    s_cmp_lg_u32 s53, 0
    s_cbranch_scc1 L_go20
    ds_read_b32 v12, v20 offset:44
    s_waitcnt lgkmcnt(0)
    v_readfirstlane_b32 s53, v12
    s_cmp_lg_u32 s53, 0
    s_cbranch_scc1 L_go20
    s_waitcnt vmcnt(2)
L_go20:
    s_waitcnt vmcnt(6)
    buffer_load_dwordx4 v[68:71], v18, s[36:39], s69 offen nt
    s_cmp_lg_u32 s53, 0
    s_cbranch_scc1 L_go21
    ds_read_b32 v12, v20 offset:44
    s_waitcnt lgkmcnt(0)
    v_readfirstlane_b32 s53, v12
    s_cmp_lg_u32 s53, 0
    s_cbranch_scc1 L_go21
    s_waitcnt vmcnt(2)
L_go21:
    s_waitcnt vmcnt(6)
    buffer_load_dwordx4 v[72:75], v17, s[32:35], s68 offen offset:0 nt
    s_cmp_lg_u32 s53, 0
    s_cbranch_scc1 L_go22
    ds_read_b32 v12, v20 offset:44
    s_waitcnt lgkmcnt(0)
    v_readfirstlane_b32 s53, v12
    s_cmp_lg_u32 s53, 0
    s_cbranch_scc1 L_go22
    s_waitcnt vmcnt(2)
L_go22:
    s_waitcnt vmcnt(6)
    buffer_load_dwordx4 v[76:79], v17, s[32:35], s68 offen offset:1152 nt
    s_cmp_lg_u32 s53, 0
    s_cbranch_scc1 L_go23
    ds_read_b32 v12, v20 offset:44
    s_waitcnt lgkmcnt(0)
    v_readfirstlane_b32 s53, v12
    s_cmp_lg_u32 s53, 0
    s_cbranch_scc1 L_go23
    s_waitcnt vmcnt(2)
L_go23:
    s_waitcnt vmcnt(6)
    buffer_load_dwordx4 v[80:83], v17, s[32:35], s68 offen offset:2304 nt
    s_cmp_lg_u32 s53, 0
    s_cbranch_scc1 L_go24
    ds_read_b32 v12, v20 offset:44
    s_waitcnt lgkmcnt(0)
    v_readfirstlane_b32 s53, v12
    s_cmp_lg_u32 s53, 0
    s_cbranch_scc1 L_go24
    s_waitcnt vmcnt(2)
L_go24:
    s_waitcnt vmcnt(6)
    buffer_load_dwordx4 v[84:87], v17, s[32:35], s68 offen offset:3456 nt
L_tail:
    ds_read_b128 v[48:51], v25
    s_waitcnt lgkmcnt(0)
    v_cmp_eq_u32 vcc, 0, v51
    s_cbranch_vccz L_wh_ok
    s_sleep 1
    s_sub_u32 s59, s59, 2
    s_cbranch_scc0 L_tail
    s_mov_b32 s59, 0
L_wh_ok:
    v_perm_b32 v32, v48, v48, v1
    v_perm_b32 v33, v48, v48, v2
    v_perm_b32 v34, v48, v48, v3
    v_perm_b32 v35, v48, v48, v4
    s_waitcnt vmcnt(8)
    s_nop 0
    v_mfma_f32_16x16x32_bf16 v[44:47], v[32:35], v[52:55], 0
    v_perm_b32 v36, v48, v48, v5
    v_perm_b32 v37, v48, v48, v6
    v_perm_b32 v38, v48, v48, v7
    v_perm_b32 v39, v48, v48, v8
    s_waitcnt vmcnt(7)
    s_nop 0
    v_mfma_f32_16x16x32_bf16 v[44:47], v[36:39], v[56:59], v[44:47]
    v_perm_b32 v32, v49, v49, v1
    v_perm_b32 v33, v49, v49, v2
    v_perm_b32 v34, v49, v49, v3
    v_perm_b32 v35, v49, v49, v4
    s_waitcnt vmcnt(6)
    s_nop 0
    v_mfma_f32_16x16x32_bf16 v[44:47], v[32:35], v[60:63], v[44:47]
    v_perm_b32 v36, v49, v49, v5
    v_perm_b32 v37, v49, v49, v6
    v_perm_b32 v38, v49, v49, v7
    v_perm_b32 v39, v49, v49, v8
    s_waitcnt vmcnt(5)
    s_nop 0
    v_mfma_f32_16x16x32_bf16 v[44:47], v[36:39], v[64:67], v[44:47]
    v_perm_b32 v32, v50, v50, v1
    v_perm_b32 v33, v50, v50, v2
    v_perm_b32 v34, v50, v50, v3
    v_perm_b32 v35, v50, v50, v4
    s_waitcnt vmcnt(4)
    s_nop 0
    v_mfma_f32_16x16x32_bf16 v[44:47], v[32:35], v[68:71], v[44:47]
L_wo:
    ds_read_b128 v[48:51], v25 offset:64
    s_waitcnt lgkmcnt(0)
    v_and_b32 v49, v49, v51
    v_cmp_ne_u32 vcc, 1, v49
    s_cbranch_vccz L_wo_ok
    s_sub_u32 s59, s59, 1
    s_cbranch_scc0 L_wo
    s_mov_b32 s59, 0
L_wo_ok:
    v_perm_b32 v32, v48, v48, v1
    v_perm_b32 v33, v48, v48, v2
    v_perm_b32 v34, v48, v48, v3
    v_perm_b32 v35, v48, v48, v4
    v_perm_b32 v36, v48, v48, v5
    v_perm_b32 v37, v48, v48, v6
    v_perm_b32 v38, v48, v48, v7
    v_perm_b32 v39, v48, v48, v8
    s_waitcnt vmcnt(3)
    v_mfma_f32_16x16x32_bf16 v[44:47], v[32:35], v[72:75], v[44:47]
    s_waitcnt vmcnt(2)
    v_mfma_f32_16x16x32_bf16 v[44:47], v[36:39], v[76:79], v[44:47]
    v_perm_b32 v32, v50, v50, v1
    v_perm_b32 v33, v50, v50, v2
    v_perm_b32 v34, v50, v50, v3
    v_perm_b32 v35, v50, v50, v4
    v_perm_b32 v36, v50, v50, v5
    v_perm_b32 v37, v50, v50, v6
    v_perm_b32 v38, v50, v50, v7
    v_perm_b32 v39, v50, v50, v8
    s_waitcnt vmcnt(1)
    v_mfma_f32_16x16x32_bf16 v[44:47], v[32:35], v[80:83], v[44:47]
    s_waitcnt vmcnt(0)
    v_mfma_f32_16x16x32_bf16 v[44:47], v[36:39], v[84:87], v[44:47]
    s_mov_b64 exec, s[70:71]
    s_cmp_eq_u32 s101, 1
    s_nop 5
    v_perm_b32 v44, v44, v31, s61
    v_perm_b32 v45, v45, v31, s62
    v_perm_b32 v46, v46, v31, s63
    v_perm_b32 v47, v47, v31, s64
    s_cbranch_scc0 L_pubC_w
    buffer_store_dwordx4 v[44:47], v24, s[48:51], s56 offen
L_pubC_r:
L_end:
    s_endpgm
L_pubO_w:
    buffer_store_dwordx4 v[88:91], v19, s[48:51], s58 offen sc1
    s_branch L_pubO_r
L_pubC_w:
    buffer_store_dwordx4 v[44:47], v24, s[48:51], s56 offen sc1
    s_branch L_pubC_r
L_service:
    v_and_b32 v0, 63, v0
    v_mov_b32 v12, 0
    v_lshlrev_b32 v11, 2, v0
    v_add_u32 v11, 66048, v11
    ds_write_b32 v11, v12
    s_waitcnt lgkmcnt(0)
    s_load_dword s60, s[30:31], 0
    s_barrier
    v_lshrrev_b32 v9, 4, v0
    v_lshlrev_b32 v15, 4, v0
    v_mov_b32 v29, 66048
    v_and_b32 v20, 3, v0
    s_mov_b64 s[48:49], s[30:31]
    s_mov_b32 s50, 1073741824
    s_mov_b32 s51, 0x20000
    s_mov_b32 s61, 0x7060500
    s_mov_b32 s62, 0x7060501
    s_mov_b32 s63, 0x7060502
    s_mov_b32 s64, 0x7060503
    s_mov_b32 s65, 0x0c0c0400
    s_mov_b32 s66, 0x0c040100
    s_mov_b32 s67, 0x04020100
    s_mov_b32 s10, 0xffffff00
    s_cmp_eq_u32 s3, 5
    s_cbranch_scc1 L_ffn
    s_getreg_b32 s28, hwreg(HW_REG_XCC_ID, 0, 4)
    v_mov_b32 v118, 1
    s_lshl_b32 s52, s100, 3
    s_add_u32 s52, s52, 4096
    s_and_b32 s14, s52, 0xffffff00
    v_lshlrev_b32 v115, 3, v0
    v_mov_b32 v25, 0
    s_waitcnt lgkmcnt(0)
    s_add_u32 s60, s60, 0x9d6b47c5
    v_mov_b32 v31, s60
    v_xor_b32 v110, s28, v31
    v_not_b32 v111, v110
    s_setprio 3
    s_mov_b64 exec, 1
    buffer_store_dwordx2 v[110:111], v25, s[48:51], s52 offen sc1
    s_mov_b64 exec, -1
    s_setprio 0
    v_add_u32 v12, 130560, v15
    v_cmp_gt_u32 vcc, 32, v0
    s_lshl_b32 s57, s100, 8
    s_and_b32 s54, s100, 0x18
    s_lshr_b32 s54, 0x01030200, s54
    s_and_b32 s54, s54, 3
    s_lshr_b32 s55, s100, 5
    s_lshl_b32 s55, s55, 2
    s_add_u32 s55, s55, s54
    s_and_b32 s54, s100, 1
    s_lshl_b32 s54, s54, 16
    s_lshl_b32 s55, s55, 11
    s_add_u32 s54, s54, s55
    s_bfe_u32 s55, s100, 0x20001
    s_lshl_b32 s55, s55, 9
    s_add_u32 s54, s54, s55
    s_lshr_b32 s55, s100, 4
    s_lshl_b32 s73, s55, 12
    v_add_u32 v12, s57, v12
    v_add_u32 v13, s54, v15
    s_mov_b32 s68, 65536
    s_add_u32 s73, s73, 65536
    v_cndmask_b32 v19, v12, v13, vcc
    v_add_u32 v30, 66400, v15
    v_lshrrev_b32 v11, 5, v0
    v_lshlrev_b32 v11, 11, v11
    v_and_b32 v12, 31, v0
    v_lshl_add_u32 v18, v12, 4, v11
    v_lshrrev_b32 v11, 5, v0
    v_lshlrev_b32 v11, 8, v11
    v_lshl_add_u32 v11, v10, 4, v11
    v_and_b32 v12, 1, v9
    v_lshl_add_u32 v11, v12, 3, v11
    v_add_u32 v26, 65536, v11
    s_lshr_b32 s54, s100, 4
    s_lshl_b32 s53, s100, 10
    s_add_u32 s53, s53, 327680
    s_lshl_b32 s58, s54, 8
    s_add_u32 s58, s58, 589824
    v_lshlrev_b32 v11, 6, v10
    v_lshl_add_u32 v113, v9, 4, v11
    v_lshlrev_b32 v114, 4, v10
    s_and_b32 s54, s100, 31
    s_lshr_b32 s29, s100, 5
    s_mul_i32 s29, s29, 18
    s_add_u32 s29, s29, s54
    s_lshl_b32 s29, s29, 12
    s_add_u32 s29, s29, 655360
    s_lshl_b32 s15, s100, 4
    s_add_u32 s15, s15, 589824
    v_lshrrev_b32 v21, 5, v0
    v_lshl_add_u32 v21, v21, 5, v29
    v_lshl_add_u32 v27, v9, 4, v29
    v_mov_b32 v129, 1
    v_mov_b32 v131, 1
    s_lshr_b32 s55, s54, 2
    s_lshl_b32 s55, s55, 7
    s_cmp_ge_u32 s54, 16
    s_cselect_b32 s70, 0, 1
    s_cselect_b32 s71, 0, 64
    s_lshr_b32 s70, s54, s70
    s_and_b32 s70, s70, 1
    s_lshl_b32 s70, s70, 2
    s_add_u32 s55, s55, s70
    s_and_b32 s70, s54, 1
    s_mul_i32 s70, s70, s71
    s_add_u32 s55, s55, s70
    v_bfrev_b32 v11, v9
    v_lshrrev_b32 v11, 30, v11
    v_and_b32 v12, 7, v0
    v_lshl_add_u32 v11, v12, 3, v11
    v_add_u32 v11, s55, v11
    v_lshlrev_b32 v125, 1, v11
    v_lshlrev_b32 v23, 3, v0
    s_lshl_b32 s7, s54, 7
    s_add_u32 s7, s7, 1261568
    v_mov_b32 v120, 0
    v_mov_b32 v121, 0x3ff00000
    s_mov_b64 s[44:45], s[26:27]
    s_mov_b32 s46, 1152
    s_mov_b32 s47, 0x20000
    s_mov_b32 s101, 0
    v_not_b32 v24, v31
    s_setprio 3
L_w1:
    ds_read_b128 v[160:163], v29
    ds_read_b128 v[144:147], v30 offset:0
    ds_read_b128 v[148:151], v30 offset:1024
    ds_read_b128 v[152:155], v30 offset:2048
    ds_read_b128 v[156:159], v30 offset:3072
    s_waitcnt lgkmcnt(0)
    v_min3_u32 v11, v160, v161, v162
    v_min_u32 v11, v11, v163
    v_cmp_le_u32 vcc, 1, v11
    s_cbranch_vccnz L_w1_ok
    s_sleep 1
    s_sub_u32 s59, s59, 2
    s_cbranch_scc0 L_w1
    s_mov_b32 s59, 0
L_w1_ok:
    v_pk_add_f32 v[144:145], v[144:145], v[148:149]
    v_pk_add_f32 v[146:147], v[146:147], v[150:151]
    v_pk_add_f32 v[152:153], v[152:153], v[156:157]
    v_pk_add_f32 v[154:155], v[154:155], v[158:159]
    v_pk_add_f32 v[136:137], v[144:145], v[152:153]
    v_pk_add_f32 v[138:139], v[146:147], v[154:155]
    v_mov_b32 v144, v136
    v_mov_b32 v148, v136
    v_mov_b32 v145, v137
    v_mov_b32 v149, v137
    v_mov_b32 v146, v138
    v_mov_b32 v150, v138
    v_mov_b32 v147, v139
    v_mov_b32 v151, v139
    s_and_b32 s54, s100, 31
    s_cmp_lt_u32 s54, 24
    s_cselect_b32 s9, 0xffff, 0
    v_permlane16_swap_b32 v144, v148
    v_permlane16_swap_b32 v145, v149
    v_permlane16_swap_b32 v146, v150
    v_permlane16_swap_b32 v147, v151
    s_mov_b32 exec_lo, 0
    v_pk_add_f32 v[136:137], v[144:145], v[148:149]
    v_pk_add_f32 v[138:139], v[146:147], v[150:151]
    s_mov_b32 exec_lo, -1
    v_perm_b32 v136, v136, v31, s61
    v_perm_b32 v137, v137, v31, s62
    v_perm_b32 v138, v138, v31, s63
    v_perm_b32 v139, v139, v31, s64
    s_mov_b32 exec_hi, s9
    buffer_store_dwordx4 v[136:139], v19, s[48:51], s68 offen
    s_mov_b32 exec_hi, 0
    buffer_load_dwordx2 v[108:109], v115, s[48:51], s14 offen sc1
    s_mov_b32 exec_hi, -1
    buffer_load_dwordx4 v[100:103], v113, s[48:51], s53 offen sc1
    s_mov_b64 exec, 0xffff
    buffer_load_dwordx4 v[104:107], v114, s[48:51], s58 offen sc1
    s_mov_b64 exec, -1
L_w2:
    ds_read_b128 v[160:163], v29
    s_waitcnt lgkmcnt(0)
    v_min3_u32 v11, v160, v161, v162
    v_min_u32 v11, v11, v163
    v_cmp_le_u32 vcc, 2, v11
    s_cbranch_vccnz L_w2_ok
    s_sleep 1
    s_sub_u32 s59, s59, 2
    s_cbranch_scc0 L_w2
    s_mov_b32 s59, 0
L_w2_ok:
    buffer_load_dwordx4 v[84:87], v18, s[48:51], s73 offen offset:0 sc1
    buffer_load_dwordx4 v[88:91], v18, s[48:51], s73 offen offset:512 sc1
    buffer_load_dwordx4 v[92:95], v18, s[48:51], s73 offen offset:1024 sc1
    buffer_load_dwordx4 v[96:99], v18, s[48:51], s73 offen offset:1536 sc1
    s_waitcnt vmcnt(6)
    s_cmp_lg_u32 s101, 0
    s_cbranch_scc1 L_id0_x
    s_mov_b32 exec_hi, 0
    v_cmp_ne_u64 vcc, v[108:109], v[110:111]
    s_cbranch_vccnz L_id0_n
    s_mov_b32 s101, 1
    s_branch L_id0_x
L_id0_n:
    s_mov_b64 exec, vcc
    v_xor_b32 v11, v108, v31
    v_xor_b32 v12, v108, v109
    v_cmp_gt_u32 vcc, 16, v11
    v_cmp_eq_u32 s[70:71], -1, v12
    s_mov_b32 exec_lo, -1
    s_and_b64 vcc, vcc, s[70:71]
    s_cbranch_scc1 L_id0_s
    buffer_load_dwordx2 v[108:109], v115, s[48:51], s14 offen sc1
    s_branch L_id0_x
L_id0_s:
    s_mov_b32 exec_hi, s9
    s_mov_b32 s101, 2
    s_add_u32 s68, s68, 1310720
    s_add_u32 s73, s73, 1310720
    buffer_store_dwordx4 v[136:139], v19, s[48:51], s68 offen sc1
L_id0_x:
    s_mov_b32 exec_hi, -1
L_pollQ:
    s_waitcnt vmcnt(0)
    s_cmp_lg_u32 s101, 0
    s_cbranch_scc1 L_pollQ_id_x
    s_mov_b32 exec_hi, 0
    v_cmp_ne_u64 vcc, v[108:109], v[110:111]
    s_cbranch_vccnz L_pollQ_id_n
    s_mov_b32 s101, 1
    s_branch L_pollQ_id_x
L_pollQ_id_n:
    s_mov_b64 exec, vcc
    v_xor_b32 v11, v108, v31
    v_xor_b32 v12, v108, v109
    v_cmp_gt_u32 vcc, 16, v11
    v_cmp_eq_u32 s[70:71], -1, v12
    s_mov_b32 exec_lo, -1
    s_and_b64 vcc, vcc, s[70:71]
    s_cbranch_scc1 L_pollQ_id_s
    buffer_load_dwordx2 v[108:109], v115, s[48:51], s14 offen sc1
    s_branch L_pollQ_id_x
L_pollQ_id_s:
    s_mov_b32 exec_hi, s9
    s_mov_b32 s101, 2
    s_add_u32 s68, s68, 1310720
    s_add_u32 s73, s73, 1310720
    buffer_store_dwordx4 v[136:139], v19, s[48:51], s68 offen sc1
L_pollQ_id_x:
    s_mov_b32 exec_hi, -1
    s_mov_b64 s[70:71], 0
    v_perm_b32 v11, v85, v84, s65
    v_perm_b32 v11, v86, v11, s66
    v_perm_b32 v11, v87, v11, s67
    v_cmp_ne_u32 vcc, v11, v31
    s_and_b64 exec, vcc, -1
    s_cbranch_execz L_pollQ_0
    s_or_b64 s[70:71], s[70:71], exec
    buffer_load_dwordx4 v[84:87], v18, s[48:51], s73 offen offset:0 sc1
L_pollQ_0:
    s_mov_b64 exec, -1
    v_perm_b32 v11, v89, v88, s65
    v_perm_b32 v11, v90, v11, s66
    v_perm_b32 v11, v91, v11, s67
    v_cmp_ne_u32 vcc, v11, v31
    s_and_b64 exec, vcc, -1
    s_cbranch_execz L_pollQ_1
    s_or_b64 s[70:71], s[70:71], exec
    buffer_load_dwordx4 v[88:91], v18, s[48:51], s73 offen offset:512 sc1
L_pollQ_1:
    s_mov_b64 exec, -1
    v_perm_b32 v11, v93, v92, s65
    v_perm_b32 v11, v94, v11, s66
    v_perm_b32 v11, v95, v11, s67
    v_cmp_ne_u32 vcc, v11, v31
    s_and_b64 exec, vcc, -1
    s_cbranch_execz L_pollQ_2
    s_or_b64 s[70:71], s[70:71], exec
    buffer_load_dwordx4 v[92:95], v18, s[48:51], s73 offen offset:1024 sc1
L_pollQ_2:
    s_mov_b64 exec, -1
    v_perm_b32 v11, v97, v96, s65
    v_perm_b32 v11, v98, v11, s66
    v_perm_b32 v11, v99, v11, s67
    v_cmp_ne_u32 vcc, v11, v31
    s_and_b64 exec, vcc, -1
    s_cbranch_execz L_pollQ_3
    s_or_b64 s[70:71], s[70:71], exec
    buffer_load_dwordx4 v[96:99], v18, s[48:51], s73 offen offset:1536 sc1
L_pollQ_3:
    s_mov_b64 exec, -1
    s_cmp_eq_u64 s[70:71], 0
    s_cbranch_scc1 L_pollQ_done
    s_sub_u32 s59, s59, 8
    s_cbranch_scc0 L_pollQ
    s_mov_b32 s59, 0
    s_waitcnt vmcnt(0)
L_pollQ_done:
    v_and_b32 v144, s10, v84
    v_and_b32 v145, s10, v85
    v_and_b32 v146, s10, v86
    v_and_b32 v147, s10, v87
    v_and_b32 v148, s10, v88
    v_and_b32 v149, s10, v89
    v_and_b32 v150, s10, v90
    v_and_b32 v151, s10, v91
    v_and_b32 v152, s10, v92
    v_and_b32 v153, s10, v93
    v_and_b32 v154, s10, v94
    v_and_b32 v155, s10, v95
    v_and_b32 v156, s10, v96
    v_and_b32 v157, s10, v97
    v_and_b32 v158, s10, v98
    v_and_b32 v159, s10, v99
    v_pk_add_f32 v[144:145], v[144:145], v[148:149]
    v_pk_add_f32 v[146:147], v[146:147], v[150:151]
    v_pk_add_f32 v[152:153], v[152:153], v[156:157]
    v_pk_add_f32 v[154:155], v[154:155], v[158:159]
    v_pk_add_f32 v[144:145], v[144:145], v[152:153]
    v_pk_add_f32 v[146:147], v[146:147], v[154:155]
    v_cvt_pk_bf16_f32 v144, v144, v145
    v_cvt_pk_bf16_f32 v145, v146, v147
    ds_write_b64 v26, v[144:145]
    s_mov_b64 exec, 1
    ds_write_b32 v29, v118 offset:16
    s_mov_b64 exec, -1
L_idfin:
    s_cmp_lg_u32 s101, 0
    s_cbranch_scc1 L_idok
    s_waitcnt vmcnt(0)
    s_cmp_lg_u32 s101, 0
    s_cbranch_scc1 L_idfin_id_x
    s_mov_b32 exec_hi, 0
    v_cmp_ne_u64 vcc, v[108:109], v[110:111]
    s_cbranch_vccnz L_idfin_id_n
    s_mov_b32 s101, 1
    s_branch L_idfin_id_x
L_idfin_id_n:
    s_mov_b64 exec, vcc
    v_xor_b32 v11, v108, v31
    v_xor_b32 v12, v108, v109
    v_cmp_gt_u32 vcc, 16, v11
    v_cmp_eq_u32 s[70:71], -1, v12
    s_mov_b32 exec_lo, -1
    s_and_b64 vcc, vcc, s[70:71]
    s_cbranch_scc1 L_idfin_id_s
    buffer_load_dwordx2 v[108:109], v115, s[48:51], s14 offen sc1
    s_branch L_idfin_id_x
L_idfin_id_s:
    s_mov_b32 exec_hi, s9
    s_mov_b32 s101, 2
    s_add_u32 s68, s68, 1310720
    s_add_u32 s73, s73, 1310720
    buffer_store_dwordx4 v[136:139], v19, s[48:51], s68 offen sc1
L_idfin_id_x:
    s_mov_b32 exec_hi, -1
    s_sub_u32 s59, s59, 8
    s_cbranch_scc0 L_idfin
    s_mov_b32 s59, 0
    s_mov_b32 s101, 2
L_idok:
    v_mov_b32 v118, s101
    s_mov_b64 exec, 1
    ds_write_b32 v29, v118 offset:24
    s_mov_b64 exec, -1
    s_mov_b32 s57, 0x3e0293ee
    s_bitcmp1_b32 s100, 3
    s_cselect_b64 s[54:55], -1, 0
L_w4:
    ds_read_b128 v[160:163], v29
    ds_read_b128 v[144:147], v21 offset:192
    ds_read_b128 v[148:151], v21 offset:208
    s_waitcnt lgkmcnt(0)
    v_min3_u32 v11, v160, v161, v162
    v_min_u32 v11, v11, v163
    v_cmp_le_u32 vcc, 4, v11
    s_cbranch_vccnz L_w4_ok
    s_sleep 1
    s_sub_u32 s59, s59, 2
    s_cbranch_scc0 L_w4
    s_mov_b32 s59, 0
L_w4_ok:
    v_max3_f32 v152, v144, v145, v146
    v_max_f32 v152, v152, v147
    v_and_b32 v152, s10, v152
    v_sub_f32 v144, v144, v152
    v_sub_f32 v145, v145, v152
    v_sub_f32 v146, v146, v152
    v_sub_f32 v147, v147, v152
    v_mul_f32 v144, s57, v144
    v_mul_f32 v145, s57, v145
    v_mul_f32 v146, s57, v146
    v_mul_f32 v147, s57, v147
    v_exp_f32 v164, v144
    v_exp_f32 v165, v145
    v_exp_f32 v166, v146
    v_exp_f32 v167, v147
    v_mov_b32 v154, v152
    v_mul_f32 v153, v164, v148
    v_fmac_f32 v153, v165, v149
    v_fmac_f32 v153, v166, v150
    v_fmac_f32 v153, v167, v151
    v_mov_b32 v155, v153
    s_nop 1
    v_permlane32_swap_b32 v152, v154
    v_permlane32_swap_b32 v153, v155
    v_perm_b32 v152, v152, v31, s61
    v_perm_b32 v153, v153, v31, s62
    v_perm_b32 v154, v154, v31, s63
    v_perm_b32 v155, v155, v31, s64
    s_mov_b64 exec, 1
    s_cmp_eq_u32 s101, 1
    s_cbranch_scc0 L_pubS_w
    buffer_store_dwordx4 v[152:155], v25, s[48:51], s15 offen
L_pubS_r:
    s_mov_b64 exec, -1
    v_lshrrev_b32 v12, 5, v0
    v_lshl_add_u32 v12, v12, 4, v29
    s_mov_b32 exec_lo, 1
    s_mov_b32 exec_hi, 1
    ds_write_b128 v12, v[164:167] offset:256
    s_mov_b64 exec, -1
    v_not_b32 v144, v31
    v_lshrrev_b32 v145, 8, v144
    v_lshrrev_b32 v146, 16, v144
    v_lshrrev_b32 v147, 24, v144
    ds_write_b128 v27, v[144:147] offset:288
    s_mov_b64 exec, 1
    ds_write_b32 v29, v31 offset:52
    ds_write_b32 v29, v118 offset:48
    s_mov_b64 exec, -1
    s_and_b32 s70, s100, 15
    s_lshl_b32 s72, 0x00010001, s70
    s_mov_b32 s73, s72
L_w5:
    ds_read_b128 v[160:163], v29
    s_waitcnt lgkmcnt(0)
    v_min3_u32 v11, v160, v161, v162
    v_min_u32 v11, v11, v163
    v_cmp_le_u32 vcc, 5, v11
    s_cbranch_vccnz L_w5_ok
    s_sleep 1
    s_sub_u32 s59, s59, 2
    s_cbranch_scc0 L_w5
    s_mov_b32 s59, 0
L_w5_ok:
    s_branch L_g1
L_g:
    s_waitcnt vmcnt(0)
L_g1:
    v_perm_b32 v11, v101, v100, s65
    v_perm_b32 v11, v102, v11, s66
    v_perm_b32 v11, v103, v11, s67
    v_cmp_ne_u32 s[68:69], v11, v31
    s_andn2_b64 exec, s[68:69], s[72:73]
    s_cbranch_execz L_g2
    buffer_load_dwordx4 v[100:103], v113, s[48:51], s53 offen sc1
L_g2:
    s_mov_b64 exec, 0xffff
    v_perm_b32 v11, v105, v104, s65
    v_perm_b32 v11, v106, v11, s66
    v_perm_b32 v11, v107, v11, s67
    v_cmp_ne_u32 vcc, v11, v31
    s_cbranch_vccz L_g5
    s_mov_b64 exec, vcc
    buffer_load_dwordx4 v[104:107], v114, s[48:51], s58 offen sc1
    s_mov_b64 exec, 1
    buffer_load_dword v24, v25, s[48:51], s7 offen sc1
    s_mov_b64 exec, -1
    s_sub_u32 s59, s59, 4
    s_cbranch_scc0 L_g
    s_mov_b32 s59, 0
L_g5:
    s_mov_b64 exec, -1
L_wg:
    ds_read_b64 v[16:17], v29 offset:32
    s_waitcnt lgkmcnt(0)
    v_cmp_eq_u32 vcc, 1, v17
    s_cbranch_vccnz L_wg_ok
    s_sleep 1
    s_sub_u32 s59, s59, 2
    s_cbranch_scc0 L_wg
    s_mov_b32 s59, 0
L_wg_ok:
    v_cndmask_b32 v11, v104, v106, s[54:55]
    v_cndmask_b32 v12, v105, v107, s[54:55]
    v_and_b32 v11, s10, v11
    v_and_b32 v12, s10, v12
    v_mov_b32 v13, v11
    s_nop 1
    v_max_f32_dpp v13, v13, v13 row_ror:8 row_mask:0xf bank_mask:0xf
    s_nop 1
    v_max_f32_dpp v13, v13, v13 row_ror:4 row_mask:0xf bank_mask:0xf
    s_nop 1
    v_max_f32_dpp v13, v13, v13 row_ror:2 row_mask:0xf bank_mask:0xf
    s_nop 1
    v_max_f32_dpp v13, v13, v13 row_ror:1 row_mask:0xf bank_mask:0xf
    v_sub_f32 v11, v11, v13
    v_mul_f32 v11, s57, v11
    v_exp_f32 v11, v11
    s_mov_b32 s70, 2
    v_mul_f32 v12, v12, v11
    v_mul_f32 v11, v11, v16
    s_nop 1
    v_add_f32_dpp v12, v12, v12 row_ror:8 row_mask:0xf bank_mask:0xf
    s_nop 1
    v_add_f32_dpp v12, v12, v12 row_ror:4 row_mask:0xf bank_mask:0xf
    s_nop 1
    v_add_f32_dpp v12, v12, v12 row_ror:2 row_mask:0xf bank_mask:0xf
    s_nop 1
    v_add_f32_dpp v12, v12, v12 row_ror:1 row_mask:0xf bank_mask:0xf
    v_rcp_f32 v12, v12
    s_nop 0
    v_mul_f32 v116, v11, v12
    v_mov_b32 v11, v116
    s_nop 1
    v_permlane16_swap_b32 v116, v11
    v_mov_b32 v11, v116
    s_nop 1
    v_permlane32_swap_b32 v116, v11
L_p0:
    s_and_b64 exec, s[68:69], s[72:73]
    s_cbranch_execz L_p1
    ds_read_b128 v[100:103], v27 offset:288
    s_waitcnt lgkmcnt(0)
L_p1:
    s_mov_b64 exec, -1
    v_perm_b32 v11, v101, v100, s65
    v_perm_b32 v11, v102, v11, s66
    v_perm_b32 v11, v103, v11, s67
    v_cmp_ne_u32 vcc, v11, v31
    s_cbranch_vccz L_gdone
    s_mov_b64 s[68:69], vcc
    s_sleep 1
    s_sub_u32 s70, s70, 1
    s_cbranch_scc0 L_p0
L_p2:
    s_andn2_b64 exec, s[68:69], s[72:73]
    s_cbranch_execz L_p3
    buffer_load_dwordx4 v[100:103], v113, s[48:51], s53 offen sc1
    s_waitcnt vmcnt(1)
L_p3:
    s_and_b64 exec, s[68:69], s[72:73]
    s_cbranch_execz L_p4
    ds_read_b128 v[100:103], v27 offset:288
    s_waitcnt lgkmcnt(0)
L_p4:
    s_mov_b64 exec, -1
    v_perm_b32 v11, v101, v100, s65
    v_perm_b32 v11, v102, v11, s66
    v_perm_b32 v11, v103, v11, s67
    v_cmp_ne_u32 vcc, v11, v31
    s_cbranch_vccz L_gdone
    s_mov_b64 s[68:69], vcc
    s_sub_u32 s59, s59, 2
    s_cbranch_scc0 L_p2
    s_mov_b32 s59, 0
L_gdone:
    v_and_b32 v144, s10, v100
    v_and_b32 v145, s10, v101
    v_and_b32 v146, s10, v102
    v_and_b32 v147, s10, v103
    v_pk_mul_f32 v[144:145], v[144:145], v[116:117] op_sel_hi:[1,0]
    v_pk_mul_f32 v[146:147], v[146:147], v[116:117] op_sel_hi:[1,0]
    s_nop 0
    v_add_f32_dpp v144, v144, v144 row_ror:8 row_mask:0xf bank_mask:0xf
    v_add_f32_dpp v145, v145, v145 row_ror:8 row_mask:0xf bank_mask:0xf
    v_add_f32_dpp v146, v146, v146 row_ror:8 row_mask:0xf bank_mask:0xf
    v_add_f32_dpp v147, v147, v147 row_ror:8 row_mask:0xf bank_mask:0xf
    v_add_f32_dpp v144, v144, v144 row_ror:4 row_mask:0xf bank_mask:0xf
    v_add_f32_dpp v145, v145, v145 row_ror:4 row_mask:0xf bank_mask:0xf
    v_add_f32_dpp v146, v146, v146 row_ror:4 row_mask:0xf bank_mask:0xf
    v_add_f32_dpp v147, v147, v147 row_ror:4 row_mask:0xf bank_mask:0xf
    v_add_f32_dpp v144, v144, v144 row_ror:2 row_mask:0xf bank_mask:0xf
    v_add_f32_dpp v145, v145, v145 row_ror:2 row_mask:0xf bank_mask:0xf
    v_add_f32_dpp v146, v146, v146 row_ror:2 row_mask:0xf bank_mask:0xf
    v_add_f32_dpp v147, v147, v147 row_ror:2 row_mask:0xf bank_mask:0xf
    v_add_f32_dpp v144, v144, v144 row_ror:1 row_mask:0xf bank_mask:0xf
    v_add_f32_dpp v145, v145, v145 row_ror:1 row_mask:0xf bank_mask:0xf
    v_add_f32_dpp v146, v146, v146 row_ror:1 row_mask:0xf bank_mask:0xf
    v_add_f32_dpp v147, v147, v147 row_ror:1 row_mask:0xf bank_mask:0xf
    s_mov_b32 exec_lo, 0x00010001
    s_mov_b32 exec_hi, 0x00010001
    v_cvt_pk_bf16_f32 v128, v144, v145
    v_cvt_pk_bf16_f32 v130, v146, v147
    ds_write_b128 v27, v[128:131] offset:128
    s_mov_b64 exec, -1
    s_setprio 0
    s_and_b32 s54, s100, 31
    s_cmp_ge_u32 s54, 18
    s_cbranch_scc1 L_att_done
    s_lshl_b32 s56, s54, 9
    s_add_u32 s56, s56, 1245184
    s_mov_b64 exec, 1
L_fl:
    v_cmp_ne_u32 vcc, v24, v31
    s_cbranch_vccz L_fl_ok
    buffer_load_dword v24, v25, s[48:51], s7 offen sc1
    s_waitcnt vmcnt(0)
    s_sub_u32 s59, s59, 4
    s_cbranch_scc0 L_fl
    s_mov_b32 s59, 0
L_fl_ok:
    s_mov_b64 exec, -1
    s_bfe_u32 s68, s60, 0x80000
    s_bfe_u32 s69, s60, 0x80008
    s_bfe_u32 s70, s60, 0x80010
    s_bfe_u32 s71, s60, 0x80018
    buffer_load_dwordx4 v[48:51], v15, s[48:51], s29 offen offset:0 sc1
    buffer_load_dwordx4 v[52:55], v15, s[48:51], s29 offen offset:1024 sc1
    buffer_load_dwordx4 v[56:59], v15, s[48:51], s29 offen offset:2048 sc1
    buffer_load_dwordx4 v[60:63], v15, s[48:51], s29 offen offset:3072 sc1
L_pollC:
    buffer_load_dwordx4 v[64:67], v15, s[48:51], s29 offen offset:0 sc1
    buffer_load_dwordx4 v[68:71], v15, s[48:51], s29 offen offset:1024 sc1
    buffer_load_dwordx4 v[72:75], v15, s[48:51], s29 offen offset:2048 sc1
    buffer_load_dwordx4 v[76:79], v15, s[48:51], s29 offen offset:3072 sc1
    s_waitcnt vmcnt(7)
    v_xor_b32 v32, s68, v48
    v_xor_b32 v33, s69, v49
    v_xor_b32 v34, s70, v50
    v_xor_b32 v35, s71, v51
    v_or3_b32 v11, v32, v33, v34
    v_or_b32 v11, v11, v35
    s_waitcnt vmcnt(6)
    v_xor_b32 v52, s68, v52
    v_xor_b32 v53, s69, v53
    v_xor_b32 v54, s70, v54
    v_xor_b32 v55, s71, v55
    v_or3_b32 v11, v11, v52, v53
    v_or3_b32 v11, v11, v54, v55
    v_pk_add_f32 v[32:33], v[32:33], v[52:53]
    v_pk_add_f32 v[34:35], v[34:35], v[54:55]
    s_waitcnt vmcnt(5)
    v_xor_b32 v56, s68, v56
    v_xor_b32 v57, s69, v57
    v_xor_b32 v58, s70, v58
    v_xor_b32 v59, s71, v59
    v_or3_b32 v11, v11, v56, v57
    v_or3_b32 v11, v11, v58, v59
    v_pk_add_f32 v[32:33], v[32:33], v[56:57]
    v_pk_add_f32 v[34:35], v[34:35], v[58:59]
    s_waitcnt vmcnt(4)
    v_xor_b32 v60, s68, v60
    v_xor_b32 v61, s69, v61
    v_xor_b32 v62, s70, v62
    v_xor_b32 v63, s71, v63
    v_or3_b32 v11, v11, v60, v61
    v_or3_b32 v11, v11, v62, v63
    v_cmp_ne_u32_sdwa vcc, v11, v25 src0_sel:BYTE_0 src1_sel:DWORD
    v_pk_add_f32 v[32:33], v[32:33], v[60:61]
    v_pk_add_f32 v[34:35], v[34:35], v[62:63]
    s_cbranch_vccz L_Cdone
    buffer_load_dwordx4 v[48:51], v15, s[48:51], s29 offen offset:0 sc1
    buffer_load_dwordx4 v[52:55], v15, s[48:51], s29 offen offset:1024 sc1
    buffer_load_dwordx4 v[56:59], v15, s[48:51], s29 offen offset:2048 sc1
    buffer_load_dwordx4 v[60:63], v15, s[48:51], s29 offen offset:3072 sc1
    s_waitcnt vmcnt(7)
    v_xor_b32 v32, s68, v64
    v_xor_b32 v33, s69, v65
    v_xor_b32 v34, s70, v66
    v_xor_b32 v35, s71, v67
    v_or3_b32 v11, v32, v33, v34
    v_or_b32 v11, v11, v35
    s_waitcnt vmcnt(6)
    v_xor_b32 v68, s68, v68
    v_xor_b32 v69, s69, v69
    v_xor_b32 v70, s70, v70
    v_xor_b32 v71, s71, v71
    v_or3_b32 v11, v11, v68, v69
    v_or3_b32 v11, v11, v70, v71
    v_pk_add_f32 v[32:33], v[32:33], v[68:69]
    v_pk_add_f32 v[34:35], v[34:35], v[70:71]
    s_waitcnt vmcnt(5)
    v_xor_b32 v72, s68, v72
    v_xor_b32 v73, s69, v73
    v_xor_b32 v74, s70, v74
    v_xor_b32 v75, s71, v75
    v_or3_b32 v11, v11, v72, v73
    v_or3_b32 v11, v11, v74, v75
    v_pk_add_f32 v[32:33], v[32:33], v[72:73]
    v_pk_add_f32 v[34:35], v[34:35], v[74:75]
    s_waitcnt vmcnt(4)
    v_xor_b32 v76, s68, v76
    v_xor_b32 v77, s69, v77
    v_xor_b32 v78, s70, v78
    v_xor_b32 v79, s71, v79
    v_or3_b32 v11, v11, v76, v77
    v_or3_b32 v11, v11, v78, v79
    v_cmp_ne_u32_sdwa vcc, v11, v25 src0_sel:BYTE_0 src1_sel:DWORD
    v_pk_add_f32 v[32:33], v[32:33], v[76:77]
    v_pk_add_f32 v[34:35], v[34:35], v[78:79]
    s_cbranch_vccz L_Cdone
    s_sub_u32 s59, s59, 8
    s_cbranch_scc0 L_pollC
    s_mov_b32 s59, 0
L_Cdone:
    s_nop 0
    v_permlane32_swap_b32 v32, v33
    v_permlane32_swap_b32 v34, v35
    v_add_f32 v32, v32, v33
    v_add_f32 v34, v34, v35
    s_nop 1
    v_permlane16_swap_b32 v32, v34
    v_add_f32 v32, v32, v34
    s_nop 1
    v_add_f32_dpp v32, v32, v32 row_ror:8 row_mask:0xf bank_mask:0xf
    s_mov_b32 exec_lo, 0xaa55aa55
    s_mov_b32 exec_hi, 0xaa55aa55
    v_cvt_f64_f32 v[120:121], v32
    s_mov_b64 exec, -1
    buffer_atomic_add_f64 v[120:121], v23, s[48:51], s56 offen sc0
    v_cvt_f64_f32 v[34:35], v32
    s_mov_b32 s70, 0xaa55aa55
    s_mov_b32 s71, s70
    s_mov_b32 s57, 0x401c0000
    s_waitcnt vmcnt(0)
    v_mov_b32_dpp v11, v121 quad_perm:[1,0,3,2] row_mask:0xf bank_mask:0xf
    v_add_f64 v[34:35], v[34:35], v[120:121]
    v_cmp_eq_u32 vcc, s57, v11
    v_cvt_f32_f64 v32, v[34:35]
    s_and_b64 exec, vcc, s[70:71]
    s_cbranch_execz L_att_done
    v_cvt_pk_bf16_f32 v32, v32, v32
    buffer_store_short v32, v125, s[44:47], 0 offen
    s_cmp_lg_u32 s54, 0
    s_cbranch_scc1 L_att_done
    s_and_b64 exec, exec, 1
    s_cbranch_execz L_att_done
    buffer_store_dword v31, v25, s[48:51], 0 offen
L_att_done:
    s_endpgm
L_pubS_w:
    buffer_store_dwordx4 v[152:155], v25, s[48:51], s15 offen sc1
    s_branch L_pubS_r
L_ffn:
    s_lshr_b32 s54, s100, 4
    s_lshl_b32 s54, s54, 24
    s_and_b32 s55, s100, 15
    s_lshl_b32 s55, s55, 16
    s_add_u32 s54, s54, s55
    s_add_u32 s54, s54, 15728640
    s_mul_i32 s55, s100, 18432
    s_mul_i32 s56, s100, 2304
    s_add_u32 s56, s56, 4718592
    s_mov_b64 exec, 1
    v_mov_b32 v13, s54
    global_load_dword v145, v13, s[6:7] nt
    v_mov_b32 v13, s54
    global_load_dword v145, v13, s[8:9] nt
    v_mov_b32 v13, s55
    global_load_dword v145, v13, s[12:13] nt
    v_mov_b32 v13, s55
    global_load_dword v145, v13, s[20:21] nt
    v_mov_b32 v13, s56
    global_load_dword v145, v13, s[20:21] nt
    s_mov_b64 exec, -1
    s_getpc_b64 s[70:71]
    s_and_b32 s70, s70, 0xfffff000
    s_sub_u32 s70, s70, 0x1000
    s_subb_u32 s71, s71, 0
    v_lshlrev_b32 v12, 7, v0
    s_and_b32 s54, s100, 31
    s_lshl_b32 s54, s54, 1
    s_lshl_b64 exec, 3, s54
    global_load_dword v144, v12, s[70:71]
    s_mov_b64 exec, -1
    s_lshl_b32 s54, s100, 4
    s_lshl_b32 s55, s100, 1
    s_add_u32 s55, s55, 4080
    v_add_u32 v11, s54, v0
    v_add_u32 v12, s55, v0
    v_cmp_gt_u32 vcc, 16, v0
    s_nop 1
    v_cndmask_b32 v11, v12, v11, vcc
    v_lshlrev_b32 v11, 1, v11
    s_mov_b64 s[40:41], s[18:19]
    s_mov_b32 s42, 9216
    s_mov_b32 s43, 0x20000
    s_mov_b64 exec, 0x3ffff
    buffer_load_ushort v123, v11, s[40:43], 0 offen
    s_mov_b64 exec, -1
    s_and_b32 s54, s100, 31
    s_sub_u32 s54, s54, 18
    s_lshl_b32 s54, s54, 3
    s_lshr_b32 s55, s100, 5
    s_add_u32 s54, s54, s55
    s_mov_b32 s6, s54
    s_mov_b64 s[32:33], s[4:5]
    s_mov_b32 s34, 1152
    s_mov_b32 s35, 0x20000
    s_mov_b64 s[36:37], s[24:25]
    s_mov_b32 s38, 1152
    s_mov_b32 s39, 0x20000
    buffer_load_dwordx4 v[128:131], v15, s[32:35], 0 offen
    buffer_load_dwordx4 v[132:135], v15, s[32:35], 0 offen offset:1024
    buffer_load_dwordx4 v[136:139], v15, s[36:39], 0 offen
    buffer_load_dwordx4 v[140:143], v15, s[36:39], 0 offen offset:1024
    s_lshr_b32 s55, s54, 2
    s_lshl_b32 s55, s55, 7
    s_cmp_ge_u32 s54, 16
    s_cselect_b32 s70, 0, 1
    s_cselect_b32 s71, 0, 64
    s_lshr_b32 s70, s54, s70
    s_and_b32 s70, s70, 1
    s_lshl_b32 s70, s70, 2
    s_add_u32 s55, s55, s70
    s_and_b32 s70, s54, 1
    s_mul_i32 s70, s70, s71
    s_add_u32 s55, s55, s70
    v_bfrev_b32 v11, v9
    v_lshrrev_b32 v11, 30, v11
    v_and_b32 v12, 7, v0
    v_lshl_add_u32 v11, v12, 3, v11
    v_add_u32 v11, s55, v11
    v_lshlrev_b32 v125, 1, v11
    s_mov_b64 s[44:45], s[22:23]
    s_mov_b32 s46, 1152
    s_mov_b32 s47, 0x20000
    buffer_load_ushort v124, v125, s[44:47], 0 offen
L_nog0:
    v_and_b32 v11, 1, v10
    v_cmp_eq_u32 vcc, 1, v11
    v_mov_b32 v12, 0x0c0c0100
    v_mov_b32 v13, 0x01000c0c
    v_cndmask_b32 v12, v12, v13, vcc
    v_mov_b32 v14, 0x0c0c0302
    v_mov_b32 v13, 0x03020c0c
    v_cndmask_b32 v13, v14, v13, vcc
    v_bfe_u32 v11, v10, 1, 2
    v_mov_b32 v14, 0x0c0c0c0c
    v_cmp_eq_u32 vcc, 0, v11
    s_nop 1
    v_cndmask_b32 v1, v14, v12, vcc
    v_cndmask_b32 v5, v14, v13, vcc
    v_cmp_eq_u32 vcc, 1, v11
    s_nop 1
    v_cndmask_b32 v2, v14, v12, vcc
    v_cndmask_b32 v6, v14, v13, vcc
    v_cmp_eq_u32 vcc, 2, v11
    s_nop 1
    v_cndmask_b32 v3, v14, v12, vcc
    v_cndmask_b32 v7, v14, v13, vcc
    v_cmp_eq_u32 vcc, 3, v11
    s_nop 1
    v_cndmask_b32 v4, v14, v12, vcc
    v_cndmask_b32 v8, v14, v13, vcc
    s_lshr_b32 s54, s100, 3
    s_lshl_b32 s54, s54, 11
    s_and_b32 s55, s100, 7
    s_lshl_b32 s55, s55, 5
    s_add_u32 s72, s54, s55
    s_add_u32 s72, s72, 131072
    v_bfe_u32 v11, v0, 2, 1
    v_lshlrev_b32 v11, 8, v11
    v_bfe_u32 v12, v0, 3, 1
    v_lshl_add_u32 v11, v12, 4, v11
    v_lshl_add_u32 v21, v20, 9, v11
    s_lshr_b32 s54, s100, 5
    s_lshl_b32 s54, s54, 13
    s_bfe_u32 s55, s100, 0x10001
    s_lshl_b32 s55, s55, 7
    s_add_u32 s54, s54, s55
    s_bfe_u32 s55, s100, 0x30002
    s_lshl_b32 s55, s55, 4
    s_add_u32 s73, s54, s55
    s_add_u32 s73, s73, 196608
    v_lshlrev_b32 v22, 8, v0
    s_and_b32 s54, s100, 31
    s_lshr_b32 s53, s100, 5
    s_mul_i32 s53, s53, 18
    s_add_u32 s53, s53, s54
    s_lshl_b32 s53, s53, 12
    s_add_u32 s53, s53, 655360
    s_cmp_ge_u32 s54, 18
    s_cselect_b32 s53, 1073741824, s53
    s_waitcnt lgkmcnt(0)
    s_add_u32 s60, s60, 0x9d6b47c5
    v_mov_b32 v31, s60
    s_lshr_b32 s7, s100, 5
    s_lshl_b32 s7, s7, 7
    s_add_u32 s7, s7, 1265664
    s_waitcnt vmcnt(0)
    v_mov_b32 v26, 0
    v_lshlrev_b32 v11, 16, v128
    v_lshlrev_b32 v12, 16, v136
    v_and_b32 v13, 0xffff0000, v128
    v_and_b32 v14, 0xffff0000, v136
    v_mul_f32 v11, v11, v12
    v_mul_f32 v13, v13, v14
    v_cvt_pk_bf16_f32 v11, v11, v13
    v_lshlrev_b32 v12, 16, v11
    v_and_b32 v13, 0xffff0000, v11
    v_add_f32 v26, v26, v12
    v_add_f32 v26, v26, v13
    v_lshlrev_b32 v11, 16, v129
    v_lshlrev_b32 v12, 16, v137
    v_and_b32 v13, 0xffff0000, v129
    v_and_b32 v14, 0xffff0000, v137
    v_mul_f32 v11, v11, v12
    v_mul_f32 v13, v13, v14
    v_cvt_pk_bf16_f32 v11, v11, v13
    v_lshlrev_b32 v12, 16, v11
    v_and_b32 v13, 0xffff0000, v11
    v_add_f32 v26, v26, v12
    v_add_f32 v26, v26, v13
    v_lshlrev_b32 v11, 16, v130
    v_lshlrev_b32 v12, 16, v138
    v_and_b32 v13, 0xffff0000, v130
    v_and_b32 v14, 0xffff0000, v138
    v_mul_f32 v11, v11, v12
    v_mul_f32 v13, v13, v14
    v_cvt_pk_bf16_f32 v11, v11, v13
    v_lshlrev_b32 v12, 16, v11
    v_and_b32 v13, 0xffff0000, v11
    v_add_f32 v26, v26, v12
    v_add_f32 v26, v26, v13
    v_lshlrev_b32 v11, 16, v131
    v_lshlrev_b32 v12, 16, v139
    v_and_b32 v13, 0xffff0000, v131
    v_and_b32 v14, 0xffff0000, v139
    v_mul_f32 v11, v11, v12
    v_mul_f32 v13, v13, v14
    v_cvt_pk_bf16_f32 v11, v11, v13
    v_lshlrev_b32 v12, 16, v11
    v_and_b32 v13, 0xffff0000, v11
    v_add_f32 v26, v26, v12
    v_add_f32 v26, v26, v13
    v_lshlrev_b32 v11, 16, v132
    v_lshlrev_b32 v12, 16, v140
    v_and_b32 v13, 0xffff0000, v132
    v_and_b32 v14, 0xffff0000, v140
    v_mul_f32 v11, v11, v12
    v_mul_f32 v13, v13, v14
    v_cvt_pk_bf16_f32 v11, v11, v13
    v_lshlrev_b32 v12, 16, v11
    v_and_b32 v13, 0xffff0000, v11
    v_add_f32 v26, v26, v12
    v_add_f32 v26, v26, v13
    v_lshlrev_b32 v11, 16, v133
    v_lshlrev_b32 v12, 16, v141
    v_and_b32 v13, 0xffff0000, v133
    v_and_b32 v14, 0xffff0000, v141
    v_mul_f32 v11, v11, v12
    v_mul_f32 v13, v13, v14
    v_cvt_pk_bf16_f32 v11, v11, v13
    v_lshlrev_b32 v12, 16, v11
    v_and_b32 v13, 0xffff0000, v11
    v_add_f32 v26, v26, v12
    v_add_f32 v26, v26, v13
    v_lshlrev_b32 v11, 16, v134
    v_lshlrev_b32 v12, 16, v142
    v_and_b32 v13, 0xffff0000, v134
    v_and_b32 v14, 0xffff0000, v142
    v_mul_f32 v11, v11, v12
    v_mul_f32 v13, v13, v14
    v_cvt_pk_bf16_f32 v11, v11, v13
    v_lshlrev_b32 v12, 16, v11
    v_and_b32 v13, 0xffff0000, v11
    v_add_f32 v26, v26, v12
    v_add_f32 v26, v26, v13
    v_lshlrev_b32 v11, 16, v135
    v_lshlrev_b32 v12, 16, v143
    v_and_b32 v13, 0xffff0000, v135
    v_and_b32 v14, 0xffff0000, v143
    v_mul_f32 v11, v11, v12
    v_mul_f32 v13, v13, v14
    v_cvt_pk_bf16_f32 v11, v11, v13
    v_lshlrev_b32 v12, 16, v11
    v_and_b32 v13, 0xffff0000, v11
    v_add_f32 v26, v26, v12
    v_add_f32 v26, v26, v13
    s_nop 1
    v_add_f32_dpp v26, v26, v26 row_ror:8 row_mask:0xf bank_mask:0xf
    s_nop 1
    v_add_f32_dpp v26, v26, v26 row_ror:4 row_mask:0xf bank_mask:0xf
    s_nop 1
    v_add_f32_dpp v26, v26, v26 row_ror:2 row_mask:0xf bank_mask:0xf
    s_nop 1
    v_add_f32_dpp v26, v26, v26 row_ror:1 row_mask:0xf bank_mask:0xf
    v_mov_b32 v11, v26
    s_nop 1
    v_permlane16_swap_b32 v26, v11
    v_add_f32 v26, v26, v11
    v_mov_b32 v11, v26
    s_nop 1
    v_permlane32_swap_b32 v26, v11
    v_add_f32 v26, v26, v11
    v_cvt_pk_bf16_f32 v26, v26, v26
    v_and_b32 v26, 0xffff0000, v26
    v_mul_f32 v26, 0xbfb8aa3b, v26
    v_exp_f32 v26, v26
    s_nop 0
    v_add_f32 v26, 1.0, v26
    v_rcp_f32 v26, v26
    v_mov_b32 v27, 1
    v_cvt_pk_bf16_f32 v26, v26, v26
    v_and_b32 v26, 0xffff0000, v26
    v_sub_f32 v28, 1.0, v26
    v_cvt_pk_bf16_f32 v28, v28, v28
    v_and_b32 v28, 0xffff0000, v28
    s_mov_b64 exec, 1
    ds_write_b64 v29, v[26:27] offset:32
    s_mov_b64 exec, -1
    v_lshlrev_b32 v124, 16, v124
    v_mul_f32 v124, v28, v124
    s_cmp_ge_u32 s6, 18
    s_cbranch_scc1 L_noinit
    v_mov_b32 v12, 0
    v_mov_b32 v13, 0
    s_mov_b32 exec_lo, 0xaa55aa55
    s_mov_b32 exec_hi, 0xaa55aa55
    v_cvt_f64_f32 v[12:13], v124
    s_mov_b64 exec, -1
    v_lshlrev_b32 v11, 3, v0
    s_lshl_b32 s54, s6, 9
    s_add_u32 s54, s54, 1245184
    s_lshl_b32 s55, s6, 7
    s_add_u32 s55, s55, 1261568
    buffer_store_dwordx2 v[12:13], v11, s[48:51], s54 offen sc1
    s_waitcnt vmcnt(0)
    s_mov_b64 exec, 1
    buffer_store_dword v31, v11, s[48:51], s55 offen sc1
    s_mov_b64 exec, -1
L_noinit:
    s_mov_b32 s8, 0xffffff
    s_mov_b32 s9, 0
    v_mov_b32 v108, 0
    v_mov_b32 v109, 0
    v_mov_b32 v110, 0
    v_mov_b32 v111, 0
L_f2:
    ds_read_b128 v[160:163], v29
    s_waitcnt lgkmcnt(0)
    v_min3_u32 v11, v160, v161, v162
    v_min_u32 v11, v11, v163
    v_cmp_le_u32 vcc, 3, v11
    s_cbranch_vccnz L_f2_ok
    s_sleep 2
    s_sub_u32 s59, s59, 2
    s_cbranch_scc0 L_f2
    s_mov_b32 s59, 0
L_f2_ok:
    s_mov_b64 exec, s[8:9]
    buffer_load_dwordx4 v[108:111], v22, s[48:51], s73 offen sc1
    s_mov_b64 exec, -1
    s_mov_b64 exec, 0xffff
    buffer_load_dwordx4 v[104:107], v21, s[48:51], s72 offen sc1
    s_mov_b64 exec, -1
L_wm:
    ds_read_b32 v16, v29 offset:24
    s_waitcnt lgkmcnt(0)
    v_cmp_ne_u32 vcc, 0, v16
    s_cbranch_vccnz L_wm_ok
    s_sleep 2
    s_sub_u32 s59, s59, 2
    s_cbranch_scc0 L_wm
    s_mov_b32 s59, 0
    v_mov_b32 v16, 2
L_wm_ok:
    s_nop 0
    v_readfirstlane_b32 s101, v16
    s_cmp_eq_u32 s101, 1
    s_cselect_b32 s54, 0, 1310720
    s_add_u32 s73, s73, s54
    s_add_u32 s72, s72, s54
L_pollH:
    s_waitcnt vmcnt(0)
    s_mov_b64 s[70:71], 0
    v_perm_b32 v11, v109, v108, s65
    v_perm_b32 v11, v110, v11, s66
    v_perm_b32 v11, v111, v11, s67
    v_cmp_ne_u32 vcc, v11, v31
    s_and_b64 exec, vcc, s[8:9]
    s_cbranch_execz L_pollH_0
    s_or_b64 s[70:71], s[70:71], exec
    buffer_load_dwordx4 v[108:111], v22, s[48:51], s73 offen sc1
L_pollH_0:
    s_mov_b64 exec, -1
    v_perm_b32 v11, v105, v104, s65
    v_perm_b32 v11, v106, v11, s66
    v_perm_b32 v11, v107, v11, s67
    v_cmp_ne_u32 vcc, v11, v31
    s_and_b64 exec, vcc, 0xffff
    s_cbranch_execz L_pollH_1
    s_or_b64 s[70:71], s[70:71], exec
    buffer_load_dwordx4 v[104:107], v21, s[48:51], s72 offen sc1
L_pollH_1:
    s_mov_b64 exec, -1
    s_cmp_eq_u64 s[70:71], 0
    s_cbranch_scc1 L_pollH_done
    s_sub_u32 s59, s59, 8
    s_cbranch_scc0 L_pollH
    s_mov_b32 s59, 0
    s_waitcnt vmcnt(0)
L_pollH_done:
    v_and_b32 v104, s10, v104
    v_and_b32 v105, s10, v105
    v_and_b32 v106, s10, v106
    v_and_b32 v107, s10, v107
    v_and_b32 v108, s10, v108
    v_and_b32 v109, s10, v109
    v_and_b32 v110, s10, v110
    v_and_b32 v111, s10, v111
    v_add_f32_dpp v104, v104, v104 quad_perm:[1,0,3,2] row_mask:0xf bank_mask:0xf
    v_add_f32_dpp v105, v105, v105 quad_perm:[1,0,3,2] row_mask:0xf bank_mask:0xf
    v_add_f32_dpp v106, v106, v106 quad_perm:[1,0,3,2] row_mask:0xf bank_mask:0xf
    v_add_f32_dpp v107, v107, v107 quad_perm:[1,0,3,2] row_mask:0xf bank_mask:0xf
    v_add_f32_dpp v104, v104, v104 quad_perm:[2,3,0,1] row_mask:0xf bank_mask:0xf
    v_add_f32_dpp v105, v105, v105 quad_perm:[2,3,0,1] row_mask:0xf bank_mask:0xf
    v_add_f32_dpp v106, v106, v106 quad_perm:[2,3,0,1] row_mask:0xf bank_mask:0xf
    v_add_f32_dpp v107, v107, v107 quad_perm:[2,3,0,1] row_mask:0xf bank_mask:0xf
    s_bitcmp1_b32 s100, 0
    s_cselect_b64 vcc, -1, 0
    v_cndmask_b32 v108, v108, v110, vcc
    v_cndmask_b32 v109, v109, v111, vcc
    s_nop 1
    v_add_f32_dpp v108, v108, v108 row_ror:8 row_mask:0xf bank_mask:0xf
    v_add_f32_dpp v109, v109, v109 row_ror:8 row_mask:0xf bank_mask:0xf
    s_nop 1
    v_add_f32_dpp v108, v108, v108 row_ror:4 row_mask:0xf bank_mask:0xf
    v_add_f32_dpp v109, v109, v109 row_ror:4 row_mask:0xf bank_mask:0xf
    s_nop 1
    v_add_f32_dpp v108, v108, v108 row_ror:2 row_mask:0xf bank_mask:0xf
    v_add_f32_dpp v109, v109, v109 row_ror:2 row_mask:0xf bank_mask:0xf
    s_nop 1
    v_add_f32_dpp v108, v108, v108 row_ror:1 row_mask:0xf bank_mask:0xf
    v_add_f32_dpp v109, v109, v109 row_ror:1 row_mask:0xf bank_mask:0xf
    v_mov_b32 v11, v108
    s_nop 1
    v_permlane16_swap_b32 v108, v11
    v_add_f32 v108, v108, v11
    v_mov_b32 v11, v108
    s_nop 1
    v_permlane32_swap_b32 v108, v11
    v_add_f32 v108, v108, v11
    v_mov_b32 v11, v109
    s_nop 1
    v_permlane16_swap_b32 v109, v11
    v_add_f32 v109, v109, v11
    v_mov_b32 v11, v109
    s_nop 1
    v_permlane32_swap_b32 v109, v11
    v_add_f32 v109, v109, v11
    v_mov_b32 v12, v104
    v_cmp_eq_u32 vcc, 1, v20
    s_nop 1
    v_cndmask_b32 v12, v12, v105, vcc
    v_cmp_eq_u32 vcc, 2, v20
    s_nop 1
    v_cndmask_b32 v12, v12, v106, vcc
    v_cmp_eq_u32 vcc, 3, v20
    s_nop 1
    v_cndmask_b32 v12, v12, v107, vcc
    v_cmp_eq_u32 vcc, 16, v0
    s_nop 1
    v_cndmask_b32 v12, v12, v108, vcc
    v_cmp_eq_u32 vcc, 17, v0
    s_nop 1
    v_cndmask_b32 v12, v12, v109, vcc
    v_cvt_pk_bf16_f32 v12, v12, v12
    v_and_b32 v12, 0xffff0000, v12
    v_lshlrev_b32 v13, 16, v123
    v_add_f32 v12, v12, v13
    v_cvt_pk_bf16_f32 v12, v12, v12
    v_and_b32 v12, 0xffff0000, v12
    v_mul_f32 v13, v12, v12
    v_mov_b32 v14, 0xc0135761
    s_mov_b32 s57, 0xbdd2d3e8
    v_fma_f32 v13, v13, s57, v14
    v_mul_f32 v13, v13, v12
    v_exp_f32 v13, v13
    v_mul_f32 v12, v12, v28
    v_add_f32 v13, 1.0, v13
    v_rcp_f32 v13, v13
    s_nop 0
    v_mul_f32 v12, v12, v13
    v_cvt_pk_bf16_f32 v12, v12, v12
    v_cmp_lt_u32 vcc, 17, v0
    s_nop 1
    v_cndmask_b32 v12, v12, 0, vcc
    v_lshrrev_b32 v11, 2, v0
    v_lshlrev_b32 v11, 4, v11
    v_lshl_add_u32 v11, v20, 1, v11
    v_lshlrev_b32 v13, 4, v20
    v_add_u32 v13, 66120, v13
    v_cmp_gt_u32 vcc, 16, v0
    v_add_u32 v11, 66112, v11
    s_nop 0
    v_cndmask_b32 v11, v13, v11, vcc
    s_mov_b64 exec, 0xfffff
    ds_write_b16 v11, v12
    s_mov_b64 exec, 15
    ds_write_b32 v13, v16 offset:4
    s_mov_b64 exec, -1
    s_movk_i32 s57, 1024
    v_lshl_add_u32 v11, v10, 4, s57
    v_cmp_gt_u32 vcc, 8, v10
    v_mov_b32 v13, 1073741824
    s_nop 0
    v_cndmask_b32 v11, v13, v11, vcc
    v_mul_u32_u24 v12, 1152, v9
    v_lshl_add_u32 v17, v12, 2, v11
    v_add_u32 v12, v12, v11
    v_cmp_gt_u32 vcc, 2, v9
    v_mov_b32 v13, 1073741824
    s_nop 0
    v_cndmask_b32 v18, v13, v12, vcc
    s_mov_b64 s[32:33], s[12:13]
    s_mov_b32 s34, 4718592
    s_mov_b32 s35, 0x20000
    s_mov_b64 s[36:37], s[20:21]
    s_mov_b32 s38, 5308416
    s_mov_b32 s39, 0x20000
    s_mul_i32 s68, s100, 18432
    s_mul_i32 s69, s100, 2304
    s_add_u32 s69, s69, 4718592
    v_lshlrev_b32 v11, 12, v9
    s_mov_b32 s70, 0x00ff00ff
    s_mov_b32 s57, 65536
    v_and_b32 v12, 7, v0
    v_lshl_add_u32 v24, v12, 4, v11
    s_mov_b32 s71, 0
    s_lshr_b32 s56, s100, 5
    s_mul_i32 s56, s56, 73728
    s_add_u32 s56, s56, s57
    s_and_b32 s57, s100, 31
    s_lshl_b32 s57, s57, 7
    s_add_u32 s56, s56, s57
    s_add_u32 s56, s56, 655360
    v_lshlrev_b32 v25, 4, v9
    v_add_u32 v25, 66112, v25
L_f3:
    ds_read_b128 v[160:163], v29
    s_waitcnt lgkmcnt(0)
    v_min3_u32 v11, v160, v161, v162
    v_min_u32 v11, v11, v163
    v_cmp_le_u32 vcc, 5, v11
    s_cbranch_vccnz L_f3_ok
    s_sleep 2
    s_sub_u32 s59, s59, 2
    s_cbranch_scc0 L_f3
    s_mov_b32 s59, 0
L_f3_ok:
    buffer_load_dwordx4 v[144:147], v15, s[48:51], s53 offen offset:0 sc1
    buffer_load_dwordx4 v[148:151], v15, s[48:51], s53 offen offset:1024 sc1
    buffer_load_dwordx4 v[152:155], v15, s[48:51], s53 offen offset:2048 sc1
    buffer_load_dwordx4 v[156:159], v15, s[48:51], s53 offen offset:3072 sc1
    buffer_load_dwordx4 v[52:55], v17, s[36:39], s68 offen offset:0 nt
    buffer_load_dwordx4 v[56:59], v17, s[36:39], s68 offen offset:1152 nt
    buffer_load_dwordx4 v[60:63], v17, s[36:39], s68 offen offset:2304 nt
    buffer_load_dwordx4 v[64:67], v17, s[36:39], s68 offen offset:3456 nt
    buffer_load_dwordx4 v[68:71], v18, s[36:39], s69 offen nt
    buffer_load_dwordx4 v[72:75], v17, s[32:35], s68 offen offset:0 nt
    buffer_load_dwordx4 v[76:79], v17, s[32:35], s68 offen offset:1152 nt
    buffer_load_dwordx4 v[80:83], v17, s[32:35], s68 offen offset:2304 nt
    buffer_load_dwordx4 v[84:87], v17, s[32:35], s68 offen offset:3456 nt
    s_branch L_tail
    .fill 1024, 4, 0xbf810000

.section .rodata,"a"
.p2align 6
.amdhsa_kernel gated_mix__sliding_block_cached__dense_activation_gelu__decode_kernel
  .amdhsa_next_free_vgpr 168
  .amdhsa_next_free_sgpr 102
  .amdhsa_accum_offset 168
  .amdhsa_group_segment_fixed_size 0
  .amdhsa_kernarg_size 112
  .amdhsa_user_sgpr_count 2
  .amdhsa_user_sgpr_kernarg_segment_ptr 1
  .amdhsa_system_sgpr_workgroup_id_x 1
.end_amdhsa_kernel
```
